```python
import torch

def _softmax(x, axis=-1):
    return torch.softmax(x, dim=axis)

def _gelu(x):
    return torch.nn.functional.gelu(x, approximate='tanh')

def _silu(x):
    return torch.nn.functional.silu(x)

def _sigmoid(x):
    return torch.sigmoid(x)

def _layernorm(x, axis=-1, eps=1e-05):
    m = x.mean(dim=axis, keepdim=True)
    v = x.var(dim=axis, keepdim=True, unbiased=False)
    return (x - m) / torch.sqrt(v + eps)

def _scatter_add(tgt, idx, src, axis=0):
    return tgt.clone().index_add_(axis, idx, src)

def _segment_sum(src, seg, n):
    out = torch.zeros((n,) + src.shape[1:], dtype=src.dtype)
    return out.index_add_(0, seg, src)

def _pad(x, pw):
    flat = tuple((v for pair in reversed(pw) for v in pair))
    return torch.nn.functional.pad(x, flat)
kernel_name = 'standalone__swin_window_attn__vision'

def setup_inputs():

    _w = lambda a: (lambda t: t.to(torch.bfloat16) if t.is_floating_point() else t)(torch.as_tensor(a))
    H = W = 224 // 7 * 7
    C, win = (192, 7)
    return {'x': _w((lambda *s: torch.randn(*s, dtype=torch.bfloat16) * 0.2)(1, H, W, C)), 'wqkv': _w((lambda *s: torch.randn(*s, dtype=torch.bfloat16) * 0.2)(C, 3 * C)), 'wo': _w((lambda *s: torch.randn(*s, dtype=torch.bfloat16) * 0.05)(C, C))}

def reference(x, wqkv, wo):
    B, H, W, C = x.shape
    win = 7
    nh, nw = (H // win, W // win)
    xw = (lambda x, *d: x.permute(*d))(x.reshape(B, nh, win, nw, win, C), 0, 1, 3, 2, 4, 5)
    xw = xw.reshape(B * nh * nw, win * win, C)
    qkv = xw @ wqkv
    q, k, v = (qkv[..., :C].clone(), qkv[..., C:2 * C].clone(), qkv[..., 2 * C:].clone())
    scale = C ** (-0.5)
    p = _softmax(torch.einsum('bqc,bkc->bqk', q, k) * scale, axis=-1)
    o = torch.einsum('bqk,bkc->bqc', p, v) @ wo
    o = (lambda x, *d: x.permute(*d))(o.reshape(B, nh, nw, win, win, C), 0, 1, 3, 2, 4, 5)
    return o.reshape(B, H, W, C)
```

```asm
; @launch grid=(256,1,1) block=(256,1,1) lds=147488
.amdgcn_target "amdgcn-amd-amdhsa--gfx950"
.text
.globl standalone__swin_window_attn__vision_kernel
.p2align 8
.type standalone__swin_window_attn__vision_kernel,@function
standalone__swin_window_attn__vision_kernel:
  s_load_dwordx8 s[44:51], s[0:1], 0
  s_load_dwordx4 s[52:55], s[0:1], 32
  s_getreg_b32 s39, hwreg(HW_REG_XCC_ID, 0, 3)
  s_cmp_ge_u32 s2, 256
  s_cbranch_scc1 L_end
  v_lshrrev_b32 v6, 6, v0
  v_and_b32 v1, 63, v0
  s_lshr_b32 s38, s2, 3
  s_and_b32 s27, s2, 7
  v_readfirstlane_b32 s21, v6
  v_and_b32 v2, 15, v1
  v_lshrrev_b32 v3, 4, v1
  v_lshrrev_b32 v4, 2, v2
  v_and_b32 v252, 3, v2
  v_lshl_add_u32 v252, v4, 3, v252
  v_mul_u32_u24 v253, 1152, v252
  v_lshl_add_u32 v253, v3, 4, v253
  v_lshlrev_b32 v255, 4, v1
  s_mul_i32 s20, s38, 602112
  s_mul_i32 s27, s27, 10752
  s_add_u32 s20, s20, s27
  s_min_u32 s38, s38, 29
  s_lshl_b32 s40, s39, 5
  s_mul_i32 s61, s39, 147456
  s_mul_i32 s27, s21, 36864
  s_add_u32 s39, s61, s27
  s_mov_b32 s43, 0
  s_mov_b32 s42, 0
  s_mov_b32 s41, 125952
  s_mov_b32 s23, 384
  s_mov_b32 s24, -49
  s_mov_b32 s25, -16128
  s_mov_b32 s26, 83328
  s_mul_i32 s22, s21, 3072
  v_lshrrev_b32 v4, 3, v1
  v_and_b32 v5, 3, v4
  v_lshrrev_b32 v4, 5, v1
  v_lshl_add_u32 v5, v4, 3, v5
  v_mul_u32_u24 v5, 1152, v5
  v_and_b32 v8, 7, v1
  v_xor_b32 v4, v3, v8
  v_lshl_add_u32 v32, v4, 4, v5
  v_xor_b32 v4, 4, v4
  v_lshl_add_u32 v33, v4, 4, v5
  v_add_u32 v33, 18432, v33
  v_and_b32 v4, 1, v6
  v_cmp_eq_u32 vcc, 1, v4
  s_nop 1
  v_cndmask_b32 v34, v32, v33, vcc
  v_xor_b32 v7, v3, v8
  v_lshlrev_b32 v7, 4, v7
  v_xor_b32 v9, 64, v7
  v_add_u32 v44, s20, v7
  v_add_u32 v45, s20, v9
  v_cndmask_b32 v7, v45, v44, vcc
  v_cndmask_b32 v16, v44, v45, vcc
  v_lshrrev_b32 v9, 3, v1
  v_lshl_add_u32 v9, v6, 3, v9
  v_add_u32 v240, -8, v9
  v_min_u32 v240, 195, v240
  v_mul_u32_u24 v4, 1338, v240
  v_lshrrev_b32 v4, 16, v4
  v_mad_i32_i24 v5, v4, s24, v240
  v_mul_u32_u24 v5, 9363, v5
  v_lshrrev_b32 v5, 16, v5
  v_mad_u32_u24 v10, v240, s23, v7
  v_mad_i32_i24 v10, v4, s25, v10
  v_mad_u32_u24 v10, v5, s26, v10
  v_add_u32 v240, 16, v9
  v_min_u32 v240, 195, v240
  v_mul_u32_u24 v4, 1338, v240
  v_lshrrev_b32 v4, 16, v4
  v_mad_i32_i24 v5, v4, s24, v240
  v_mul_u32_u24 v5, 9363, v5
  v_lshrrev_b32 v5, 16, v5
  v_mad_u32_u24 v11, v240, s23, v16
  v_mad_i32_i24 v11, v4, s25, v11
  v_mad_u32_u24 v11, v5, s26, v11
  v_add_u32 v240, 40, v9
  v_min_u32 v240, 195, v240
  v_mul_u32_u24 v4, 1338, v240
  v_lshrrev_b32 v4, 16, v4
  v_mad_i32_i24 v5, v4, s24, v240
  v_mul_u32_u24 v5, 9363, v5
  v_lshrrev_b32 v5, 16, v5
  v_mad_u32_u24 v12, v240, s23, v7
  v_mad_i32_i24 v12, v4, s25, v12
  v_mad_u32_u24 v12, v5, s26, v12
  v_add_u32 v240, 64, v9
  v_min_u32 v240, 195, v240
  v_mul_u32_u24 v4, 1338, v240
  v_lshrrev_b32 v4, 16, v4
  v_mad_i32_i24 v5, v4, s24, v240
  v_mul_u32_u24 v5, 9363, v5
  v_lshrrev_b32 v5, 16, v5
  v_mad_u32_u24 v13, v240, s23, v16
  v_mad_i32_i24 v13, v4, s25, v13
  v_mad_u32_u24 v13, v5, s26, v13
  v_lshrrev_b32 v241, 1, v2
  v_xor_b32 v241, v3, v241
  v_and_b32 v242, 7, v2
  v_lshlrev_b32 v242, 3, v242
  v_add_u32 v4, v242, v241
  v_xor_b32 v5, 4, v241
  v_add_u32 v5, v242, v5
  v_lshlrev_b32 v4, 4, v4
  v_lshlrev_b32 v5, 4, v5
  v_lshrrev_b32 v241, 3, v2
  v_mul_u32_u24 v241, 3072, v241
  v_add_u32 v18, v4, v241
  v_add_u32 v19, v5, v241
  v_add_u32 v35, 76800, v18
  v_add_u32 v36, 76800, v19
  s_waitcnt lgkmcnt(0)
  s_mov_b32 s16, s46
  s_and_b32 s17, s47, 0xffff
  s_mov_b32 s18, 221184
  s_mov_b32 s19, 0x00020000
  s_mov_b32 s4, s44
  s_and_b32 s5, s45, 0xffff
  s_mov_b32 s6, 19267584
  s_mov_b32 s7, 0x00020000
  s_mov_b32 s56, s48
  s_and_b32 s57, s49, 0xffff
  s_mov_b32 s58, 73728
  s_mov_b32 s59, 0x00020000
  s_mov_b32 s8, s54
  s_and_b32 s9, s55, 0xffff
  s_mov_b32 s10, 268435456
  s_mov_b32 s11, 0x00020000
  s_mov_b32 s92, s52
  s_and_b32 s93, s53, 0xffff
  s_mov_b32 s94, 256
  s_mov_b32 s95, 0x00020000
  s_cmp_ge_u32 s38, 18
  s_cbranch_scc1 L_jobn
  s_mul_i32 s62, s38, 43
  s_lshr_b32 s62, s62, 8
  s_mul_i32 s63, s62, 6
  s_sub_u32 s63, s38, s63
  s_lshr_b32 s65, s21, 1
  s_mul_i32 s66, s63, 36864
  s_mul_i32 s27, s65, 4608
  s_add_u32 s66, s66, s27
  s_lshl_b32 s64, s21, 5
  s_lshl_b32 s27, s62, 2
  s_add_u32 s64, s64, s27
  s_lshl_b32 s65, s65, 5
  s_and_b32 s27, s21, 1
  s_lshl_b32 s27, s27, 2
  s_add_u32 s65, s65, s27
  s_add_u32 s65, s65, 128
  s_cmp_eq_u32 s62, 2
  s_cselect_b32 s64, s65, s64
  s_mul_i32 s64, s64, 1152
  s_add_u32 s64, s64, 384
  s_lshl_b32 s65, s38, 10
  s_add_u32 s65, s65, s61
  s_lshl_b32 s67, s22, 1
  s_add_u32 m0, s22, 76800
  s_nop 0
  buffer_load_dwordx4 v34, s[16:19], s66 offen offset:0 lds
  s_add_u32 m0, s22, 77696
  s_nop 0
  buffer_load_dwordx4 v34, s[16:19], s66 offen offset:128 lds
  s_add_u32 m0, s22, 78592
  s_nop 0
  buffer_load_dwordx4 v34, s[16:19], s66 offen offset:256 lds
  s_add_u32 m0, s67, 89088
  s_nop 0
  buffer_load_dwordx4 v32, s[16:19], s64 offen offset:0 lds
  s_add_u32 m0, s67, 92160
  s_nop 0
  buffer_load_dwordx4 v33, s[16:19], s64 offen offset:0 lds
  s_add_u32 m0, s67, 89984
  s_nop 0
  buffer_load_dwordx4 v32, s[16:19], s64 offen offset:128 lds
  s_add_u32 m0, s67, 93056
  s_nop 0
  buffer_load_dwordx4 v33, s[16:19], s64 offen offset:128 lds
  s_add_u32 m0, s67, 90880
  s_nop 0
  buffer_load_dwordx4 v32, s[16:19], s64 offen offset:256 lds
  s_add_u32 m0, s67, 93952
  s_nop 0
  buffer_load_dwordx4 v33, s[16:19], s64 offen offset:256 lds
  v_add_u32 v37, s67, v35
  v_add_u32 v38, s67, v36
  v_add_u32 v43, 125952, v255
  v_lshl_add_u32 v43, v6, 10, v43
  s_cmp_eq_u32 s21, 0
  s_cbranch_scc1 L_jm_w0
  s_add_u32 m0, s22, -3072
  s_nop 0
  buffer_load_dwordx4 v10, s[4:7], 0 offen offset:0 nt lds
  s_add_u32 m0, s22, -2176
  s_nop 0
  buffer_load_dwordx4 v10, s[4:7], 0 offen offset:128 nt lds
  s_add_u32 m0, s22, -1280
  s_nop 0
  buffer_load_dwordx4 v10, s[4:7], 0 offen offset:256 nt lds
  s_add_u32 m0, s22, 6144
  s_nop 0
  buffer_load_dwordx4 v11, s[4:7], 0 offen offset:0 nt lds
  s_add_u32 m0, s22, 7040
  s_nop 0
  buffer_load_dwordx4 v11, s[4:7], 0 offen offset:128 nt lds
  s_add_u32 m0, s22, 7936
  s_nop 0
  buffer_load_dwordx4 v11, s[4:7], 0 offen offset:256 nt lds
  s_add_u32 m0, s22, 15360
  s_nop 0
  buffer_load_dwordx4 v12, s[4:7], 0 offen offset:0 nt lds
  s_add_u32 m0, s22, 16256
  s_nop 0
  buffer_load_dwordx4 v12, s[4:7], 0 offen offset:128 nt lds
  s_add_u32 m0, s22, 17152
  s_nop 0
  buffer_load_dwordx4 v12, s[4:7], 0 offen offset:256 nt lds
  s_add_u32 m0, s22, 24576
  s_nop 0
  buffer_load_dwordx4 v13, s[4:7], 0 offen offset:0 nt lds
  s_add_u32 m0, s22, 25472
  s_nop 0
  buffer_load_dwordx4 v13, s[4:7], 0 offen offset:128 nt lds
  s_add_u32 m0, s22, 26368
  s_nop 0
  buffer_load_dwordx4 v13, s[4:7], 0 offen offset:256 nt lds
  s_waitcnt vmcnt(12)
  s_barrier
  s_branch L_jm_e
L_jm_w0:
  s_waitcnt vmcnt(0)
  s_barrier
L_jm_e:
  ds_read_b128 v[192:195], v37 offset:12288
  ds_read_b128 v[48:51], v35 offset:0
  ds_read_b128 v[72:75], v35 offset:6144
  ds_read_b128 v[196:199], v38 offset:12288
  ds_read_b128 v[52:55], v36 offset:0
  ds_read_b128 v[76:79], v36 offset:6144
  ds_read_b128 v[200:203], v37 offset:13312
  ds_read_b128 v[56:59], v35 offset:1024
  ds_read_b128 v[80:83], v35 offset:7168
  ds_read_b128 v[204:207], v38 offset:13312
  ds_read_b128 v[60:63], v36 offset:1024
  ds_read_b128 v[84:87], v36 offset:7168
  ds_read_b128 v[208:211], v37 offset:14336
  ds_read_b128 v[64:67], v35 offset:2048
  ds_read_b128 v[88:91], v35 offset:8192
  ds_read_b128 v[212:215], v38 offset:14336
  ds_read_b128 v[68:71], v36 offset:2048
  ds_read_b128 v[92:95], v36 offset:8192
  s_waitcnt lgkmcnt(15)
  v_mfma_f32_16x16x32_bf16 v[216:219], v[48:51], v[192:195], 0
  v_mfma_f32_16x16x32_bf16 v[220:223], v[72:75], v[192:195], 0
  s_waitcnt lgkmcnt(13)
  v_mfma_f32_16x16x32_bf16 v[216:219], v[52:55], v[196:199], v[216:219]
  s_waitcnt lgkmcnt(12)
  v_mfma_f32_16x16x32_bf16 v[220:223], v[76:79], v[196:199], v[220:223]
  s_waitcnt lgkmcnt(10)
  v_mfma_f32_16x16x32_bf16 v[216:219], v[56:59], v[200:203], v[216:219]
  s_waitcnt lgkmcnt(9)
  v_mfma_f32_16x16x32_bf16 v[220:223], v[80:83], v[200:203], v[220:223]
  s_waitcnt lgkmcnt(7)
  v_mfma_f32_16x16x32_bf16 v[216:219], v[60:63], v[204:207], v[216:219]
  s_waitcnt lgkmcnt(6)
  v_mfma_f32_16x16x32_bf16 v[220:223], v[84:87], v[204:207], v[220:223]
  s_waitcnt lgkmcnt(4)
  v_mfma_f32_16x16x32_bf16 v[216:219], v[64:67], v[208:211], v[216:219]
  s_waitcnt lgkmcnt(3)
  v_mfma_f32_16x16x32_bf16 v[220:223], v[88:91], v[208:211], v[220:223]
  s_waitcnt lgkmcnt(1)
  v_mfma_f32_16x16x32_bf16 v[216:219], v[68:71], v[212:215], v[216:219]
  s_waitcnt lgkmcnt(0)
  v_mfma_f32_16x16x32_bf16 v[220:223], v[92:95], v[212:215], v[220:223]
  s_mov_b32 s27, 0x3dd53b95
  s_nop 4
  v_mul_f32 v216, s27, v216
  v_mul_f32 v217, s27, v217
  v_mul_f32 v218, s27, v218
  v_mul_f32 v219, s27, v219
  v_mul_f32 v220, s27, v220
  v_mul_f32 v221, s27, v221
  v_mul_f32 v222, s27, v222
  v_mul_f32 v223, s27, v223
  v_cvt_pk_bf16_f32 v232, v216, v217
  v_cvt_pk_bf16_f32 v233, v218, v219
  v_cvt_pk_bf16_f32 v234, v220, v221
  v_cvt_pk_bf16_f32 v235, v222, v223
  ds_write_b128 v43, v[232:235] offset:0
  s_waitcnt lgkmcnt(0)
  s_barrier
  s_cmp_lg_u32 s21, 0
  s_cbranch_scc1 L_others
  ds_read_b128 v[48:51], v43 offset:0
  ds_read_b128 v[52:55], v43 offset:1024
  ds_read_b128 v[56:59], v43 offset:2048
  ds_read_b128 v[60:63], v43 offset:3072
  s_add_u32 s27, s65, 0
  s_waitcnt lgkmcnt(3)
  buffer_store_dwordx4 v[48:51], v255, s[8:11], s27 offen offset:0
  s_add_u32 s27, s65, 36864
  s_waitcnt lgkmcnt(2)
  buffer_store_dwordx4 v[52:55], v255, s[8:11], s27 offen offset:0
  s_add_u32 s27, s65, 73728
  s_waitcnt lgkmcnt(1)
  buffer_store_dwordx4 v[56:59], v255, s[8:11], s27 offen offset:0
  s_add_u32 s27, s65, 110592
  s_waitcnt lgkmcnt(0)
  buffer_store_dwordx4 v[60:63], v255, s[8:11], s27 offen offset:0
  s_branch L_w0
L_jobn:
  s_sub_u32 s63, s38, 18
  s_mul_i32 s62, s63, 86
  s_lshr_b32 s62, s62, 8
  s_mul_i32 s27, s62, 3
  s_sub_u32 s63, s63, s27
  s_lshl_b32 s63, s63, 1
  s_lshr_b32 s27, s21, 1
  s_add_u32 s63, s63, s27
  s_mul_i32 s66, s63, 36864
  s_and_b32 s27, s21, 1
  s_mul_i32 s67, s27, 4608
  s_add_u32 s66, s66, s67
  s_add_u32 s66, s66, 768
  s_lshl_b32 s65, s63, 10
  s_add_u32 s65, s65, s61
  s_mul_i32 s27, s62, 36864
  s_add_u32 s65, s65, s27
  s_add_u32 s65, s65, 18432
  s_mul_i32 s27, s62, 96
  s_min_u32 s64, s27, 256
  s_sub_u32 s62, s27, s64
  s_lshr_b32 s62, s62, 4
  s_mul_i32 s27, s21, 18432
  s_add_u32 s64, s64, s27
  s_lshl_b32 s67, s22, 1
  v_lshrrev_b32 v4, 3, v1
  v_mul_u32_u24 v4, 384, v4
  v_and_b32 v5, 1, v3
  v_lshlrev_b32 v5, 2, v5
  v_xor_b32 v5, v5, v8
  v_lshl_add_u32 v39, v5, 4, v4
  v_xor_b32 v5, 2, v5
  v_lshl_add_u32 v40, v5, 4, v4
  s_add_u32 s27, s64, 0
  s_add_u32 m0, s67, 101376
  s_nop 0
  buffer_load_dwordx4 v39, s[56:59], s27 offen offset:0 lds
  s_add_u32 s27, s64, 3072
  s_add_u32 m0, s67, 102400
  s_nop 0
  buffer_load_dwordx4 v40, s[56:59], s27 offen offset:0 lds
  s_add_u32 s27, s64, 6144
  s_add_u32 m0, s67, 103424
  s_nop 0
  buffer_load_dwordx4 v39, s[56:59], s27 offen offset:0 lds
  s_add_u32 s27, s64, 9216
  s_add_u32 m0, s67, 104448
  s_nop 0
  buffer_load_dwordx4 v40, s[56:59], s27 offen offset:0 lds
  s_add_u32 s27, s64, 12288
  s_add_u32 m0, s67, 105472
  s_nop 0
  buffer_load_dwordx4 v39, s[56:59], s27 offen offset:0 lds
  s_add_u32 s27, s64, 15360
  s_add_u32 m0, s67, 106496
  s_nop 0
  buffer_load_dwordx4 v40, s[56:59], s27 offen offset:0 lds
  s_add_u32 m0, s67, 76800
  s_nop 0
  buffer_load_dwordx4 v32, s[16:19], s66 offen offset:0 lds
  s_add_u32 m0, s67, 79872
  s_nop 0
  buffer_load_dwordx4 v33, s[16:19], s66 offen offset:0 lds
  s_add_u32 m0, s67, 77696
  s_nop 0
  buffer_load_dwordx4 v32, s[16:19], s66 offen offset:128 lds
  s_add_u32 m0, s67, 80768
  s_nop 0
  buffer_load_dwordx4 v33, s[16:19], s66 offen offset:128 lds
  s_add_u32 m0, s67, 78592
  s_nop 0
  buffer_load_dwordx4 v32, s[16:19], s66 offen offset:256 lds
  s_add_u32 m0, s67, 81664
  s_nop 0
  buffer_load_dwordx4 v33, s[16:19], s66 offen offset:256 lds
  v_lshrrev_b32 v4, 2, v2
  v_lshl_add_u32 v41, v3, 3, v4
  v_lshlrev_b32 v41, 7, v41
  v_add_u32 v41, 101376, v41
  v_lshrrev_b32 v4, 3, v2
  v_lshlrev_b32 v4, 2, v4
  v_and_b32 v5, 1, v3
  v_lshl_add_u32 v4, v5, 1, v4
  v_and_b32 v5, 3, v2
  v_and_b32 v240, 1, v2
  v_lshl_add_u32 v42, v240, 3, v41
  v_lshrrev_b32 v240, 1, v5
  v_add_u32 v240, 4, v240
  v_add_u32 v240, s62, v240
  v_xor_b32 v240, v240, v4
  v_lshl_add_u32 v42, v240, 4, v42
  v_add_u32 v5, s62, v5
  v_xor_b32 v5, v5, v4
  v_lshl_add_u32 v41, v5, 4, v41
  v_add_u32 v37, s67, v35
  v_add_u32 v38, s67, v36
  v_lshrrev_b32 v4, 1, v6
  v_mul_u32_u24 v4, 3072, v4
  v_and_b32 v5, 1, v6
  v_lshl_add_u32 v4, v5, 3, v4
  v_add3_u32 v43, v4, v255, s41
  s_cmp_eq_u32 s21, 0
  s_cbranch_scc1 L_jn_w0
  s_add_u32 m0, s22, -3072
  s_nop 0
  buffer_load_dwordx4 v10, s[4:7], 0 offen offset:0 nt lds
  s_add_u32 m0, s22, -2176
  s_nop 0
  buffer_load_dwordx4 v10, s[4:7], 0 offen offset:128 nt lds
  s_add_u32 m0, s22, -1280
  s_nop 0
  buffer_load_dwordx4 v10, s[4:7], 0 offen offset:256 nt lds
  s_add_u32 m0, s22, 6144
  s_nop 0
  buffer_load_dwordx4 v11, s[4:7], 0 offen offset:0 nt lds
  s_add_u32 m0, s22, 7040
  s_nop 0
  buffer_load_dwordx4 v11, s[4:7], 0 offen offset:128 nt lds
  s_add_u32 m0, s22, 7936
  s_nop 0
  buffer_load_dwordx4 v11, s[4:7], 0 offen offset:256 nt lds
  s_add_u32 m0, s22, 15360
  s_nop 0
  buffer_load_dwordx4 v12, s[4:7], 0 offen offset:0 nt lds
  s_add_u32 m0, s22, 16256
  s_nop 0
  buffer_load_dwordx4 v12, s[4:7], 0 offen offset:128 nt lds
  s_add_u32 m0, s22, 17152
  s_nop 0
  buffer_load_dwordx4 v12, s[4:7], 0 offen offset:256 nt lds
  s_add_u32 m0, s22, 24576
  s_nop 0
  buffer_load_dwordx4 v13, s[4:7], 0 offen offset:0 nt lds
  s_add_u32 m0, s22, 25472
  s_nop 0
  buffer_load_dwordx4 v13, s[4:7], 0 offen offset:128 nt lds
  s_add_u32 m0, s22, 26368
  s_nop 0
  buffer_load_dwordx4 v13, s[4:7], 0 offen offset:256 nt lds
  s_waitcnt vmcnt(12)
  s_barrier
  s_branch L_jn_e
L_jn_w0:
  s_waitcnt vmcnt(0)
  s_barrier
L_jn_e:
  ds_read_b128 v[48:51], v37 offset:0
  ds_read_b64_tr_b16 v[72:73], v41 offset:0
  ds_read_b64_tr_b16 v[74:75], v41 offset:512
  ds_read_b64_tr_b16 v[96:97], v41 offset:8
  ds_read_b64_tr_b16 v[98:99], v41 offset:520
  ds_read_b64_tr_b16 v[120:121], v42 offset:0
  ds_read_b64_tr_b16 v[122:123], v42 offset:512
  ds_read_b128 v[52:55], v38 offset:0
  ds_read_b64_tr_b16 v[76:77], v41 offset:4096
  ds_read_b64_tr_b16 v[78:79], v41 offset:4608
  ds_read_b64_tr_b16 v[100:101], v41 offset:4104
  ds_read_b64_tr_b16 v[102:103], v41 offset:4616
  ds_read_b64_tr_b16 v[124:125], v42 offset:4096
  ds_read_b64_tr_b16 v[126:127], v42 offset:4608
  s_waitcnt lgkmcnt(11)
  v_mfma_f32_16x16x32_bf16 v[216:219], v[48:51], v[72:75], 0
  s_waitcnt lgkmcnt(9)
  v_mfma_f32_16x16x32_bf16 v[220:223], v[48:51], v[96:99], 0
  s_waitcnt lgkmcnt(7)
  v_mfma_f32_16x16x32_bf16 v[224:227], v[48:51], v[120:123], 0
  ds_read_b128 v[56:59], v37 offset:1024
  ds_read_b64_tr_b16 v[80:81], v41 offset:8192
  ds_read_b64_tr_b16 v[82:83], v41 offset:8704
  ds_read_b64_tr_b16 v[104:105], v41 offset:8200
  ds_read_b64_tr_b16 v[106:107], v41 offset:8712
  ds_read_b64_tr_b16 v[128:129], v42 offset:8192
  ds_read_b64_tr_b16 v[130:131], v42 offset:8704
  s_waitcnt lgkmcnt(11)
  v_mfma_f32_16x16x32_bf16 v[216:219], v[52:55], v[76:79], v[216:219]
  s_waitcnt lgkmcnt(9)
  v_mfma_f32_16x16x32_bf16 v[220:223], v[52:55], v[100:103], v[220:223]
  s_waitcnt lgkmcnt(7)
  v_mfma_f32_16x16x32_bf16 v[224:227], v[52:55], v[124:127], v[224:227]
  ds_read_b128 v[60:63], v38 offset:1024
  ds_read_b64_tr_b16 v[84:85], v41 offset:12288
  ds_read_b64_tr_b16 v[86:87], v41 offset:12800
  ds_read_b64_tr_b16 v[108:109], v41 offset:12296
  ds_read_b64_tr_b16 v[110:111], v41 offset:12808
  ds_read_b64_tr_b16 v[132:133], v42 offset:12288
  ds_read_b64_tr_b16 v[134:135], v42 offset:12800
  s_waitcnt lgkmcnt(11)
  v_mfma_f32_16x16x32_bf16 v[216:219], v[56:59], v[80:83], v[216:219]
  s_waitcnt lgkmcnt(9)
  v_mfma_f32_16x16x32_bf16 v[220:223], v[56:59], v[104:107], v[220:223]
  s_waitcnt lgkmcnt(7)
  v_mfma_f32_16x16x32_bf16 v[224:227], v[56:59], v[128:131], v[224:227]
  ds_read_b128 v[64:67], v37 offset:2048
  ds_read_b64_tr_b16 v[88:89], v41 offset:16384
  ds_read_b64_tr_b16 v[90:91], v41 offset:16896
  ds_read_b64_tr_b16 v[112:113], v41 offset:16392
  ds_read_b64_tr_b16 v[114:115], v41 offset:16904
  ds_read_b64_tr_b16 v[136:137], v42 offset:16384
  ds_read_b64_tr_b16 v[138:139], v42 offset:16896
  s_waitcnt lgkmcnt(11)
  v_mfma_f32_16x16x32_bf16 v[216:219], v[60:63], v[84:87], v[216:219]
  s_waitcnt lgkmcnt(9)
  v_mfma_f32_16x16x32_bf16 v[220:223], v[60:63], v[108:111], v[220:223]
  s_waitcnt lgkmcnt(7)
  v_mfma_f32_16x16x32_bf16 v[224:227], v[60:63], v[132:135], v[224:227]
  ds_read_b128 v[68:71], v38 offset:2048
  ds_read_b64_tr_b16 v[92:93], v41 offset:20480
  ds_read_b64_tr_b16 v[94:95], v41 offset:20992
  ds_read_b64_tr_b16 v[116:117], v41 offset:20488
  ds_read_b64_tr_b16 v[118:119], v41 offset:21000
  ds_read_b64_tr_b16 v[140:141], v42 offset:20480
  ds_read_b64_tr_b16 v[142:143], v42 offset:20992
  s_waitcnt lgkmcnt(11)
  v_mfma_f32_16x16x32_bf16 v[216:219], v[64:67], v[88:91], v[216:219]
  s_waitcnt lgkmcnt(9)
  v_mfma_f32_16x16x32_bf16 v[220:223], v[64:67], v[112:115], v[220:223]
  s_waitcnt lgkmcnt(7)
  v_mfma_f32_16x16x32_bf16 v[224:227], v[64:67], v[136:139], v[224:227]
  s_waitcnt lgkmcnt(4)
  v_mfma_f32_16x16x32_bf16 v[216:219], v[68:71], v[92:95], v[216:219]
  s_waitcnt lgkmcnt(2)
  v_mfma_f32_16x16x32_bf16 v[220:223], v[68:71], v[116:119], v[220:223]
  s_waitcnt lgkmcnt(0)
  v_mfma_f32_16x16x32_bf16 v[224:227], v[68:71], v[140:143], v[224:227]
  s_nop 3
  v_cvt_pk_bf16_f32 v232, v216, v217
  v_cvt_pk_bf16_f32 v233, v218, v219
  ds_write_b64 v43, v[232:233] offset:0
  v_cvt_pk_bf16_f32 v234, v220, v221
  v_cvt_pk_bf16_f32 v235, v222, v223
  ds_write_b64 v43, v[234:235] offset:1024
  v_cvt_pk_bf16_f32 v236, v224, v225
  v_cvt_pk_bf16_f32 v237, v226, v227
  ds_write_b64 v43, v[236:237] offset:2048
  s_add_u32 s38, s38, 2
  s_waitcnt lgkmcnt(0)
  s_barrier
  s_cmp_lg_u32 s21, 0
  s_cbranch_scc1 L_others
  ds_read_b128 v[48:51], v43 offset:0
  ds_read_b128 v[52:55], v43 offset:1024
  ds_read_b128 v[56:59], v43 offset:2048
  ds_read_b128 v[60:63], v43 offset:3072
  ds_read_b128 v[64:67], v43 offset:4096
  ds_read_b128 v[68:71], v43 offset:5120
  s_add_u32 s27, s65, 0
  s_waitcnt lgkmcnt(5)
  buffer_store_dwordx4 v[48:51], v255, s[8:11], s27 offen offset:0
  s_add_u32 s27, s65, 6144
  s_waitcnt lgkmcnt(4)
  buffer_store_dwordx4 v[52:55], v255, s[8:11], s27 offen offset:0
  s_add_u32 s27, s65, 12288
  s_waitcnt lgkmcnt(3)
  buffer_store_dwordx4 v[56:59], v255, s[8:11], s27 offen offset:0
  s_add_u32 s27, s65, 1024
  s_waitcnt lgkmcnt(2)
  buffer_store_dwordx4 v[60:63], v255, s[8:11], s27 offen offset:0
  s_add_u32 s27, s65, 7168
  s_waitcnt lgkmcnt(1)
  buffer_store_dwordx4 v[64:67], v255, s[8:11], s27 offen offset:0
  s_add_u32 s27, s65, 13312
  s_waitcnt lgkmcnt(0)
  buffer_store_dwordx4 v[68:71], v255, s[8:11], s27 offen offset:0
  s_branch L_w0
L_fallback:
  s_mov_b32 s42, 1
  s_mov_b32 s43, 1
  s_mov_b32 s38, 0
  s_add_u32 s39, s2, 8
  s_mul_i32 s39, s39, 147456
  s_mul_i32 s27, s21, 36864
  s_add_u32 s39, s39, s27
  v_mov_b32 v246, 0
  s_waitcnt vmcnt(0)
  s_waitcnt lgkmcnt(0)
  s_nop 7
  s_nop 7
L_fb_m:
  s_mul_i32 s62, s38, 43
  s_lshr_b32 s62, s62, 8
  s_mul_i32 s63, s62, 6
  s_sub_u32 s63, s38, s63
  s_mul_i32 s66, s63, 36864
  s_add_u32 s67, s66, 4608
  s_lshl_b32 s64, s21, 5
  s_lshl_b32 s27, s62, 2
  s_add_u32 s64, s64, s27
  s_lshr_b32 s65, s21, 1
  s_lshl_b32 s65, s65, 5
  s_and_b32 s27, s21, 1
  s_lshl_b32 s27, s27, 2
  s_add_u32 s65, s65, s27
  s_add_u32 s65, s65, 128
  s_cmp_eq_u32 s62, 2
  s_cselect_b32 s64, s65, s64
  s_mul_i32 s64, s64, 1152
  s_lshl_b32 s65, s38, 10
  s_add_u32 s65, s65, s39
  buffer_load_dwordx4 v[48:51], v253, s[16:19], s66 offen offset:0
  buffer_load_dwordx4 v[192:195], v253, s[16:19], s64 offen offset:384
  buffer_load_dwordx4 v[72:75], v253, s[16:19], s67 offen offset:0
  buffer_load_dwordx4 v[52:55], v253, s[16:19], s66 offen offset:64
  buffer_load_dwordx4 v[196:199], v253, s[16:19], s64 offen offset:448
  buffer_load_dwordx4 v[76:79], v253, s[16:19], s67 offen offset:64
  buffer_load_dwordx4 v[56:59], v253, s[16:19], s66 offen offset:128
  buffer_load_dwordx4 v[200:203], v253, s[16:19], s64 offen offset:512
  buffer_load_dwordx4 v[80:83], v253, s[16:19], s67 offen offset:128
  buffer_load_dwordx4 v[60:63], v253, s[16:19], s66 offen offset:192
  buffer_load_dwordx4 v[204:207], v253, s[16:19], s64 offen offset:576
  buffer_load_dwordx4 v[84:87], v253, s[16:19], s67 offen offset:192
  buffer_load_dwordx4 v[64:67], v253, s[16:19], s66 offen offset:256
  buffer_load_dwordx4 v[208:211], v253, s[16:19], s64 offen offset:640
  buffer_load_dwordx4 v[88:91], v253, s[16:19], s67 offen offset:256
  buffer_load_dwordx4 v[68:71], v253, s[16:19], s66 offen offset:320
  buffer_load_dwordx4 v[212:215], v253, s[16:19], s64 offen offset:704
  buffer_load_dwordx4 v[92:95], v253, s[16:19], s67 offen offset:320
  s_waitcnt vmcnt(16)
  v_mfma_f32_16x16x32_bf16 v[216:219], v[48:51], v[192:195], 0
  s_waitcnt vmcnt(15)
  v_mfma_f32_16x16x32_bf16 v[220:223], v[72:75], v[192:195], 0
  s_waitcnt vmcnt(13)
  v_mfma_f32_16x16x32_bf16 v[216:219], v[52:55], v[196:199], v[216:219]
  s_waitcnt vmcnt(12)
  v_mfma_f32_16x16x32_bf16 v[220:223], v[76:79], v[196:199], v[220:223]
  s_waitcnt vmcnt(10)
  v_mfma_f32_16x16x32_bf16 v[216:219], v[56:59], v[200:203], v[216:219]
  s_waitcnt vmcnt(9)
  v_mfma_f32_16x16x32_bf16 v[220:223], v[80:83], v[200:203], v[220:223]
  s_waitcnt vmcnt(7)
  v_mfma_f32_16x16x32_bf16 v[216:219], v[60:63], v[204:207], v[216:219]
  s_waitcnt vmcnt(6)
  v_mfma_f32_16x16x32_bf16 v[220:223], v[84:87], v[204:207], v[220:223]
  s_waitcnt vmcnt(4)
  v_mfma_f32_16x16x32_bf16 v[216:219], v[64:67], v[208:211], v[216:219]
  s_waitcnt vmcnt(3)
  v_mfma_f32_16x16x32_bf16 v[220:223], v[88:91], v[208:211], v[220:223]
  s_waitcnt vmcnt(1)
  v_mfma_f32_16x16x32_bf16 v[216:219], v[68:71], v[212:215], v[216:219]
  s_waitcnt vmcnt(0)
  v_mfma_f32_16x16x32_bf16 v[220:223], v[92:95], v[212:215], v[220:223]
  s_mov_b32 s27, 0x3dd53b95
  s_nop 4
  v_mul_f32 v216, s27, v216
  v_mul_f32 v217, s27, v217
  v_mul_f32 v218, s27, v218
  v_mul_f32 v219, s27, v219
  v_mul_f32 v220, s27, v220
  v_mul_f32 v221, s27, v221
  v_mul_f32 v222, s27, v222
  v_mul_f32 v223, s27, v223
  v_cvt_pk_bf16_f32 v232, v216, v217
  v_cvt_pk_bf16_f32 v233, v218, v219
  v_cvt_pk_bf16_f32 v234, v220, v221
  v_cvt_pk_bf16_f32 v235, v222, v223
  buffer_store_dwordx4 v[232:235], v255, s[8:11], s65 offen offset:0
  s_waitcnt vmcnt(0)
  s_add_u32 s38, s38, 1
  s_cmp_lt_u32 s38, 18
  s_cbranch_scc1 L_fb_m
L_fb_n:
  s_sub_u32 s63, s38, 18
  s_mul_i32 s62, s63, 86
  s_lshr_b32 s62, s62, 8
  s_mul_i32 s27, s62, 3
  s_lshl_b32 s65, s63, 11
  s_add_u32 s65, s65, s39
  s_add_u32 s65, s65, 18432
  s_sub_u32 s63, s63, s27
  s_mul_i32 s66, s63, 73728
  s_add_u32 s66, s66, 768
  s_mul_i32 s64, s21, 48
  s_lshl_b32 s27, s62, 2
  s_cmp_eq_u32 s62, 2
  s_cselect_b32 s27, 32, s27
  s_cselect_b64 vcc, -1, 0
  s_add_u32 s64, s64, s27
  v_cndmask_b32 v254, v252, v2, vcc
  v_add_u32 v254, s64, v254
  v_mul_u32_u24 v243, 3072, v3
  v_lshl_add_u32 v254, v254, 1, v243
  s_mov_b32 s67, 0
  buffer_load_ushort v144, v254, s[56:59], s67 offen offset:0
  buffer_load_ushort v145, v254, s[56:59], s67 offen offset:384
  buffer_load_ushort v146, v254, s[56:59], s67 offen offset:768
  buffer_load_ushort v147, v254, s[56:59], s67 offen offset:1152
  buffer_load_ushort v148, v254, s[56:59], s67 offen offset:1536
  buffer_load_ushort v149, v254, s[56:59], s67 offen offset:1920
  buffer_load_ushort v150, v254, s[56:59], s67 offen offset:2304
  buffer_load_ushort v151, v254, s[56:59], s67 offen offset:2688
  s_mov_b32 s67, 12288
  buffer_load_ushort v152, v254, s[56:59], s67 offen offset:0
  buffer_load_ushort v153, v254, s[56:59], s67 offen offset:384
  buffer_load_ushort v154, v254, s[56:59], s67 offen offset:768
  buffer_load_ushort v155, v254, s[56:59], s67 offen offset:1152
  buffer_load_ushort v156, v254, s[56:59], s67 offen offset:1536
  buffer_load_ushort v157, v254, s[56:59], s67 offen offset:1920
  buffer_load_ushort v158, v254, s[56:59], s67 offen offset:2304
  buffer_load_ushort v159, v254, s[56:59], s67 offen offset:2688
  s_mov_b32 s67, 24576
  buffer_load_ushort v160, v254, s[56:59], s67 offen offset:0
  buffer_load_ushort v161, v254, s[56:59], s67 offen offset:384
  buffer_load_ushort v162, v254, s[56:59], s67 offen offset:768
  buffer_load_ushort v163, v254, s[56:59], s67 offen offset:1152
  buffer_load_ushort v164, v254, s[56:59], s67 offen offset:1536
  buffer_load_ushort v165, v254, s[56:59], s67 offen offset:1920
  buffer_load_ushort v166, v254, s[56:59], s67 offen offset:2304
  buffer_load_ushort v167, v254, s[56:59], s67 offen offset:2688
  s_mov_b32 s67, 36864
  buffer_load_ushort v168, v254, s[56:59], s67 offen offset:0
  buffer_load_ushort v169, v254, s[56:59], s67 offen offset:384
  buffer_load_ushort v170, v254, s[56:59], s67 offen offset:768
  buffer_load_ushort v171, v254, s[56:59], s67 offen offset:1152
  buffer_load_ushort v172, v254, s[56:59], s67 offen offset:1536
  buffer_load_ushort v173, v254, s[56:59], s67 offen offset:1920
  buffer_load_ushort v174, v254, s[56:59], s67 offen offset:2304
  buffer_load_ushort v175, v254, s[56:59], s67 offen offset:2688
  s_mov_b32 s67, 49152
  buffer_load_ushort v176, v254, s[56:59], s67 offen offset:0
  buffer_load_ushort v177, v254, s[56:59], s67 offen offset:384
  buffer_load_ushort v178, v254, s[56:59], s67 offen offset:768
  buffer_load_ushort v179, v254, s[56:59], s67 offen offset:1152
  buffer_load_ushort v180, v254, s[56:59], s67 offen offset:1536
  buffer_load_ushort v181, v254, s[56:59], s67 offen offset:1920
  buffer_load_ushort v182, v254, s[56:59], s67 offen offset:2304
  buffer_load_ushort v183, v254, s[56:59], s67 offen offset:2688
  s_mov_b32 s67, 61440
  buffer_load_ushort v184, v254, s[56:59], s67 offen offset:0
  buffer_load_ushort v185, v254, s[56:59], s67 offen offset:384
  buffer_load_ushort v186, v254, s[56:59], s67 offen offset:768
  buffer_load_ushort v187, v254, s[56:59], s67 offen offset:1152
  buffer_load_ushort v188, v254, s[56:59], s67 offen offset:1536
  buffer_load_ushort v189, v254, s[56:59], s67 offen offset:1920
  buffer_load_ushort v190, v254, s[56:59], s67 offen offset:2304
  buffer_load_ushort v191, v254, s[56:59], s67 offen offset:2688
  s_add_u32 s67, s66, 0
  buffer_load_dwordx4 v[48:51], v253, s[16:19], s67 offen offset:0
  buffer_load_dwordx4 v[52:55], v253, s[16:19], s67 offen offset:64
  buffer_load_dwordx4 v[56:59], v253, s[16:19], s67 offen offset:128
  buffer_load_dwordx4 v[60:63], v253, s[16:19], s67 offen offset:192
  buffer_load_dwordx4 v[64:67], v253, s[16:19], s67 offen offset:256
  buffer_load_dwordx4 v[68:71], v253, s[16:19], s67 offen offset:320
  s_add_u32 s67, s66, 4608
  buffer_load_dwordx4 v[72:75], v253, s[16:19], s67 offen offset:0
  buffer_load_dwordx4 v[76:79], v253, s[16:19], s67 offen offset:64
  buffer_load_dwordx4 v[80:83], v253, s[16:19], s67 offen offset:128
  buffer_load_dwordx4 v[84:87], v253, s[16:19], s67 offen offset:192
  buffer_load_dwordx4 v[88:91], v253, s[16:19], s67 offen offset:256
  buffer_load_dwordx4 v[92:95], v253, s[16:19], s67 offen offset:320
  s_add_u32 s67, s66, 36864
  buffer_load_dwordx4 v[96:99], v253, s[16:19], s67 offen offset:0
  buffer_load_dwordx4 v[100:103], v253, s[16:19], s67 offen offset:64
  buffer_load_dwordx4 v[104:107], v253, s[16:19], s67 offen offset:128
  buffer_load_dwordx4 v[108:111], v253, s[16:19], s67 offen offset:192
  buffer_load_dwordx4 v[112:115], v253, s[16:19], s67 offen offset:256
  buffer_load_dwordx4 v[116:119], v253, s[16:19], s67 offen offset:320
  s_add_u32 s67, s66, 41472
  buffer_load_dwordx4 v[120:123], v253, s[16:19], s67 offen offset:0
  buffer_load_dwordx4 v[124:127], v253, s[16:19], s67 offen offset:64
  buffer_load_dwordx4 v[128:131], v253, s[16:19], s67 offen offset:128
  buffer_load_dwordx4 v[132:135], v253, s[16:19], s67 offen offset:192
  buffer_load_dwordx4 v[136:139], v253, s[16:19], s67 offen offset:256
  buffer_load_dwordx4 v[140:143], v253, s[16:19], s67 offen offset:320
  s_waitcnt vmcnt(63)
  v_lshl_or_b32 v192, v145, 16, v144
  v_lshl_or_b32 v193, v147, 16, v146
  v_lshl_or_b32 v194, v149, 16, v148
  v_lshl_or_b32 v195, v151, 16, v150
  s_waitcnt vmcnt(62)
  v_lshl_or_b32 v196, v153, 16, v152
  s_waitcnt vmcnt(60)
  v_lshl_or_b32 v197, v155, 16, v154
  s_waitcnt vmcnt(58)
  v_lshl_or_b32 v198, v157, 16, v156
  s_waitcnt vmcnt(56)
  v_lshl_or_b32 v199, v159, 16, v158
  s_waitcnt vmcnt(54)
  v_lshl_or_b32 v200, v161, 16, v160
  s_waitcnt vmcnt(52)
  v_lshl_or_b32 v201, v163, 16, v162
  s_waitcnt vmcnt(50)
  v_lshl_or_b32 v202, v165, 16, v164
  s_waitcnt vmcnt(48)
  v_lshl_or_b32 v203, v167, 16, v166
  s_waitcnt vmcnt(46)
  v_lshl_or_b32 v204, v169, 16, v168
  s_waitcnt vmcnt(44)
  v_lshl_or_b32 v205, v171, 16, v170
  s_waitcnt vmcnt(42)
  v_lshl_or_b32 v206, v173, 16, v172
  s_waitcnt vmcnt(40)
  v_lshl_or_b32 v207, v175, 16, v174
  s_waitcnt vmcnt(38)
  v_lshl_or_b32 v208, v177, 16, v176
  s_waitcnt vmcnt(36)
  v_lshl_or_b32 v209, v179, 16, v178
  s_waitcnt vmcnt(34)
  v_lshl_or_b32 v210, v181, 16, v180
  s_waitcnt vmcnt(32)
  v_lshl_or_b32 v211, v183, 16, v182
  s_waitcnt vmcnt(30)
  v_lshl_or_b32 v212, v185, 16, v184
  s_waitcnt vmcnt(28)
  v_lshl_or_b32 v213, v187, 16, v186
  s_waitcnt vmcnt(26)
  v_lshl_or_b32 v214, v189, 16, v188
  s_waitcnt vmcnt(24)
  v_lshl_or_b32 v215, v191, 16, v190
  s_waitcnt vmcnt(23)
  v_mfma_f32_16x16x32_bf16 v[216:219], v[48:51], v[192:195], 0
  s_waitcnt vmcnt(17)
  v_mfma_f32_16x16x32_bf16 v[220:223], v[72:75], v[192:195], 0
  v_mfma_f32_16x16x32_bf16 v[216:219], v[52:55], v[196:199], v[216:219]
  s_waitcnt vmcnt(16)
  v_mfma_f32_16x16x32_bf16 v[220:223], v[76:79], v[196:199], v[220:223]
  v_mfma_f32_16x16x32_bf16 v[216:219], v[56:59], v[200:203], v[216:219]
  s_waitcnt vmcnt(15)
  v_mfma_f32_16x16x32_bf16 v[220:223], v[80:83], v[200:203], v[220:223]
  v_mfma_f32_16x16x32_bf16 v[216:219], v[60:63], v[204:207], v[216:219]
  s_waitcnt vmcnt(14)
  v_mfma_f32_16x16x32_bf16 v[220:223], v[84:87], v[204:207], v[220:223]
  v_mfma_f32_16x16x32_bf16 v[216:219], v[64:67], v[208:211], v[216:219]
  s_waitcnt vmcnt(13)
  v_mfma_f32_16x16x32_bf16 v[220:223], v[88:91], v[208:211], v[220:223]
  v_mfma_f32_16x16x32_bf16 v[216:219], v[68:71], v[212:215], v[216:219]
  s_waitcnt vmcnt(12)
  v_mfma_f32_16x16x32_bf16 v[220:223], v[92:95], v[212:215], v[220:223]
  s_waitcnt vmcnt(11)
  v_mfma_f32_16x16x32_bf16 v[224:227], v[96:99], v[192:195], 0
  s_waitcnt vmcnt(5)
  v_mfma_f32_16x16x32_bf16 v[228:231], v[120:123], v[192:195], 0
  v_mfma_f32_16x16x32_bf16 v[224:227], v[100:103], v[196:199], v[224:227]
  s_waitcnt vmcnt(4)
  v_mfma_f32_16x16x32_bf16 v[228:231], v[124:127], v[196:199], v[228:231]
  v_mfma_f32_16x16x32_bf16 v[224:227], v[104:107], v[200:203], v[224:227]
  s_waitcnt vmcnt(3)
  v_mfma_f32_16x16x32_bf16 v[228:231], v[128:131], v[200:203], v[228:231]
  v_mfma_f32_16x16x32_bf16 v[224:227], v[108:111], v[204:207], v[224:227]
  s_waitcnt vmcnt(2)
  v_mfma_f32_16x16x32_bf16 v[228:231], v[132:135], v[204:207], v[228:231]
  v_mfma_f32_16x16x32_bf16 v[224:227], v[112:115], v[208:211], v[224:227]
  s_waitcnt vmcnt(1)
  v_mfma_f32_16x16x32_bf16 v[228:231], v[136:139], v[208:211], v[228:231]
  v_mfma_f32_16x16x32_bf16 v[224:227], v[116:119], v[212:215], v[224:227]
  s_waitcnt vmcnt(0)
  v_mfma_f32_16x16x32_bf16 v[228:231], v[140:143], v[212:215], v[228:231]
  v_cvt_pk_bf16_f32 v232, v216, v217
  v_cvt_pk_bf16_f32 v233, v218, v219
  v_cvt_pk_bf16_f32 v234, v220, v221
  v_cvt_pk_bf16_f32 v235, v222, v223
  buffer_store_dwordx4 v[232:235], v255, s[8:11], s65 offen offset:0
  s_nop 0
  v_cvt_pk_bf16_f32 v236, v224, v225
  v_cvt_pk_bf16_f32 v237, v226, v227
  v_cvt_pk_bf16_f32 v238, v228, v229
  v_cvt_pk_bf16_f32 v239, v230, v231
  buffer_store_dwordx4 v[236:239], v255, s[8:11], s65 offen offset:1024
  s_waitcnt vmcnt(0)
  s_add_u32 s38, s38, 1
  s_cmp_lt_u32 s38, 27
  s_cbranch_scc1 L_fb_n
  v_add_u32 v17, s39, v255
  s_branch L_segA
L_nslow:
  s_mov_b32 s41, 4000
L_polln:
  buffer_load_dword v243, v244, s[92:95], s40 offen sc1
  s_waitcnt vmcnt(0)
  v_and_b32 v247, v243, v246
  v_cmp_ne_u32 vcc, v247, v246
  s_nop 1
  s_cmp_eq_u64 vcc, 0
  s_cbranch_scc1 L_polln_ok
  s_sleep 1
  s_sub_u32 s41, s41, 1
  s_cmp_lg_u32 s41, 0
  s_cbranch_scc1 L_polln
  s_branch L_fallback
L_w0:
  v_add_u32 v17, s39, v255
  v_and_b32 v244, 7, v1
  v_mov_b32 v247, 0x01010101
  v_cmp_gt_u32 vcc, 4, v244
  s_nop 1
  v_cndmask_b32 v245, 0, v247, vcc
  v_cmp_lt_u32 vcc, 4, v244
  s_nop 1
  v_cndmask_b32 v246, 0, v247, vcc
  v_mov_b32 v247, 0x0101
  v_cmp_eq_u32 vcc, 4, v244
  s_nop 1
  v_cndmask_b32 v245, v245, v247, vcc
  v_lshlrev_b32 v244, 2, v244
  s_mov_b32 s96, 4096
  s_mov_b32 s97, 8192
  s_mov_b32 s98, 12288
  s_mov_b32 s99, 16384
  s_mov_b32 s100, 20480
  s_mov_b32 s101, 24576
  s_mov_b32 s3, 28672
  s_mov_b32 s60, 32768
  v_mov_b32 v8, v16
  v_add_u32 v240, 144, v9
  v_min_u32 v240, 195, v240
  v_mul_u32_u24 v4, 1338, v240
  v_lshrrev_b32 v4, 16, v4
  v_mad_i32_i24 v5, v4, s24, v240
  v_mul_u32_u24 v5, 9363, v5
  v_lshrrev_b32 v5, 16, v5
  v_mad_u32_u24 v10, v240, s23, v8
  v_mad_i32_i24 v10, v4, s25, v10
  v_mad_u32_u24 v10, v5, s26, v10
  s_add_u32 s27, s21, 22
  s_min_u32 s27, s27, 24
  s_mul_i32 s37, s27, 3072
  s_lshl_b32 s67, s27, 3
  s_bitcmp1_b32 s27, 0
  s_cselect_b64 vcc, -1, 0
  v_cndmask_b32 v7, v44, v45, vcc
  v_lshrrev_b32 v240, 3, v1
  v_add_u32 v240, s67, v240
  v_min_u32 v240, 195, v240
  v_mul_u32_u24 v4, 1338, v240
  v_lshrrev_b32 v4, 16, v4
  v_mad_i32_i24 v5, v4, s24, v240
  v_mul_u32_u24 v5, 9363, v5
  v_lshrrev_b32 v5, 16, v5
  v_mad_u32_u24 v11, v240, s23, v7
  v_mad_i32_i24 v11, v4, s25, v11
  v_mad_u32_u24 v11, v5, s26, v11
  v_add_u32 v20, 61440, v18
  v_add_u32 v21, 61440, v19
  v_lshrrev_b32 v7, 4, v242
  v_xor_b32 v7, v3, v7
  v_add_u32 v4, v242, v7
  v_xor_b32 v5, 4, v7
  v_add_u32 v5, v242, v5
  v_lshlrev_b32 v4, 4, v4
  v_lshlrev_b32 v5, 4, v5
  v_add_u32 v22, 73728, v4
  v_add_u32 v23, 73728, v5
  s_mov_b32 s12, s50
  s_and_b32 s13, s51, 0xffff
  s_mov_b32 s14, 19267584
  s_mov_b32 s15, 0x00020000
  v_add_u32 v27, 76800, v255
  v_lshl_add_u32 v24, v6, 10, v27
  v_lshrrev_b32 v5, 1, v6
  v_lshl_add_u32 v25, v5, 10, v27
  v_and_b32 v5, 1, v6
  v_lshl_add_u32 v25, v5, 3, v25
  v_add_u32 v25, 4096, v25
  v_add_u32 v29, 125952, v255
  v_lshl_add_u32 v28, v6, 11, v29
  s_mov_b32 s36, 0xf149f2ca
  v_mov_b32 v4, s36
  v_cmp_eq_u32 vcc, 0, v3
  s_nop 1
  v_cndmask_b32 v30, 0, v4, vcc
  v_cndmask_b32_e64 v31, v4, 0, vcc
  v_cmp_le_u32_e64 s[28:29], 1, v2
  v_cmp_le_u32_e64 s[30:31], 2, v2
  v_cmp_le_u32_e64 s[32:33], 3, v2
  v_cmp_le_u32_e64 s[34:35], 4, v2
  v_mul_u32_u24 v47, 96, v6
  v_lshl_add_u32 v47, v3, 4, v47
  v_add_u32 v47, s20, v47
  v_lshlrev_b32 v4, 3, v3
  v_sub_u32 v45, 64, v4
  v_mov_b32 v46, 0x7f000000
  v_add_u32 v248, 144, v2
  v_min_u32 v248, 195, v248
  v_mul_u32_u24 v249, 1338, v248
  v_lshrrev_b32 v249, 16, v249
  v_mad_i32_i24 v250, v249, s24, v248
  v_mul_u32_u24 v250, 9363, v250
  v_lshrrev_b32 v250, 16, v250
  v_mad_u32_u24 v41, v248, s23, v47
  v_mad_i32_i24 v41, v249, s25, v41
  v_mad_u32_u24 v41, v250, s26, v41
  v_add_u32 v248, 160, v2
  v_min_u32 v248, 195, v248
  v_mul_u32_u24 v249, 1338, v248
  v_lshrrev_b32 v249, 16, v249
  v_mad_i32_i24 v250, v249, s24, v248
  v_mul_u32_u24 v250, 9363, v250
  v_lshrrev_b32 v250, 16, v250
  v_mad_u32_u24 v42, v248, s23, v47
  v_mad_i32_i24 v42, v249, s25, v42
  v_mad_u32_u24 v42, v250, s26, v42
  v_add_u32 v248, 176, v2
  v_min_u32 v248, 195, v248
  v_mul_u32_u24 v249, 1338, v248
  v_lshrrev_b32 v249, 16, v249
  v_mad_i32_i24 v250, v249, s24, v248
  v_mul_u32_u24 v250, 9363, v250
  v_lshrrev_b32 v250, 16, v250
  v_mad_u32_u24 v43, v248, s23, v47
  v_mad_i32_i24 v43, v249, s25, v43
  v_mad_u32_u24 v43, v250, s26, v43
  v_add_u32 v248, 192, v2
  v_min_u32 v248, 195, v248
  v_mul_u32_u24 v249, 1338, v248
  v_lshrrev_b32 v249, 16, v249
  v_mad_i32_i24 v250, v249, s24, v248
  v_mul_u32_u24 v250, 9363, v250
  v_lshrrev_b32 v250, 16, v250
  v_mad_u32_u24 v44, v248, s23, v47
  v_mad_i32_i24 v44, v249, s25, v44
  v_mad_u32_u24 v44, v250, s26, v44
  v_mul_u32_u24 v12, 400, v2
  v_mul_u32_u24 v248, 96, v6
  v_add_u32 v12, v12, v248
  v_lshl_add_u32 v12, v3, 4, v12
  v_add_u32 v13, v12, v45
  v_add_u32 v248, 0, v0
  v_mul_u32_u24 v249, 2731, v248
  v_lshrrev_b32 v249, 16, v249
  v_add_u32 v249, v249, v248
  v_lshlrev_b32 v32, 4, v249
  v_mul_u32_u24 v250, 1561, v248
  v_lshrrev_b32 v250, 18, v250
  v_lshl_add_u32 v249, v248, 4, s20
  v_mad_u32_u24 v37, v250, s26, v249
  v_add_u32 v248, 256, v0
  v_mul_u32_u24 v249, 2731, v248
  v_lshrrev_b32 v249, 16, v249
  v_add_u32 v249, v249, v248
  v_lshlrev_b32 v33, 4, v249
  v_mul_u32_u24 v250, 1561, v248
  v_lshrrev_b32 v250, 18, v250
  v_lshl_add_u32 v249, v248, 4, s20
  v_mad_u32_u24 v38, v250, s26, v249
  v_add_u32 v248, 512, v0
  v_mul_u32_u24 v249, 2731, v248
  v_lshrrev_b32 v249, 16, v249
  v_add_u32 v249, v249, v248
  v_lshlrev_b32 v34, 4, v249
  v_mul_u32_u24 v250, 1561, v248
  v_lshrrev_b32 v250, 18, v250
  v_lshl_add_u32 v249, v248, 4, s20
  v_mad_u32_u24 v39, v250, s26, v249
  v_add_u32 v248, 768, v0
  v_mul_u32_u24 v249, 2731, v248
  v_lshrrev_b32 v249, 16, v249
  v_add_u32 v249, v249, v248
  v_lshlrev_b32 v35, 4, v249
  v_mul_u32_u24 v250, 1561, v248
  v_lshrrev_b32 v250, 18, v250
  v_lshl_add_u32 v249, v248, 4, s20
  v_mad_u32_u24 v40, v250, s26, v249
  v_add_u32 v248, 1024, v0
  v_cmp_gt_u32 vcc, 1176, v248
  v_min_u32 v248, 1175, v248
  v_mul_u32_u24 v249, 2731, v248
  v_lshrrev_b32 v249, 16, v249
  v_add_u32 v249, v249, v248
  v_lshlrev_b32 v36, 4, v249
  v_mul_u32_u24 v250, 1561, v248
  v_lshrrev_b32 v250, 18, v250
  v_lshl_add_u32 v249, v248, 4, s20
  v_mad_u32_u24 v14, v250, s26, v249
  v_cndmask_b32 v14, v46, v14, vcc
  v_mov_b32 v16, 142336
  s_add_u32 s27, s21, 0
  s_and_b32 s27, s27, 7
  s_mul_i32 s27, s27, 6144
  v_add_u32 v26, s27, v27
  v_mov_b32 v4, 134144
  s_waitcnt vmcnt(0)
  s_add_u32 s27, s38, s40
  v_mov_b32 v243, 1
  s_mov_b64 exec, 1
  buffer_store_byte v243, off, s[92:95], s27
  s_mov_b64 exec, -1
  s_mov_b32 s41, 4000
L_pollm:
  buffer_load_dword v243, v244, s[92:95], s40 offen sc1
  s_waitcnt vmcnt(0)
  v_and_b32 v247, v243, v245
  v_cmp_ne_u32 vcc, v247, v245
  s_nop 1
  s_cmp_eq_u64 vcc, 0
  s_cbranch_scc1 L_pollm_ok
  s_sleep 1
  s_sub_u32 s41, s41, 1
  s_cmp_lg_u32 s41, 0
  s_cbranch_scc1 L_pollm
  s_mov_b32 s43, 1
L_pollm_ok:
  v_mov_b32 v5, s43
  ds_write_b32 v4, v5 offset:0
  s_branch L_common
L_others:
  v_add_u32 v240, 88, v9
  v_min_u32 v240, 195, v240
  v_mul_u32_u24 v4, 1338, v240
  v_lshrrev_b32 v4, 16, v4
  v_mad_i32_i24 v5, v4, s24, v240
  v_mul_u32_u24 v5, 9363, v5
  v_lshrrev_b32 v5, 16, v5
  v_mad_u32_u24 v14, v240, s23, v7
  v_mad_i32_i24 v14, v4, s25, v14
  v_mad_u32_u24 v14, v5, s26, v14
  s_add_u32 m0, s22, 33792
  s_nop 0
  buffer_load_dwordx4 v14, s[4:7], 0 offen offset:0 nt lds
  s_add_u32 m0, s22, 34688
  s_nop 0
  buffer_load_dwordx4 v14, s[4:7], 0 offen offset:128 nt lds
  s_add_u32 m0, s22, 35584
  s_nop 0
  buffer_load_dwordx4 v14, s[4:7], 0 offen offset:256 nt lds
  v_add_u32 v240, 112, v9
  v_min_u32 v240, 195, v240
  v_mul_u32_u24 v4, 1338, v240
  v_lshrrev_b32 v4, 16, v4
  v_mad_i32_i24 v5, v4, s24, v240
  v_mul_u32_u24 v5, 9363, v5
  v_lshrrev_b32 v5, 16, v5
  v_mad_u32_u24 v15, v240, s23, v16
  v_mad_i32_i24 v15, v4, s25, v15
  v_mad_u32_u24 v15, v5, s26, v15
  s_add_u32 m0, s22, 43008
  s_nop 0
  buffer_load_dwordx4 v15, s[4:7], 0 offen offset:0 nt lds
  s_add_u32 m0, s22, 43904
  s_nop 0
  buffer_load_dwordx4 v15, s[4:7], 0 offen offset:128 nt lds
  s_add_u32 m0, s22, 44800
  s_nop 0
  buffer_load_dwordx4 v15, s[4:7], 0 offen offset:256 nt lds
  v_add_u32 v17, s39, v255
  v_and_b32 v244, 7, v1
  v_mov_b32 v247, 0x01010101
  v_cmp_gt_u32 vcc, 4, v244
  s_nop 1
  v_cndmask_b32 v245, 0, v247, vcc
  v_cmp_lt_u32 vcc, 4, v244
  s_nop 1
  v_cndmask_b32 v246, 0, v247, vcc
  v_mov_b32 v247, 0x0101
  v_cmp_eq_u32 vcc, 4, v244
  s_nop 1
  v_cndmask_b32 v245, v245, v247, vcc
  v_lshlrev_b32 v244, 2, v244
  s_mov_b32 s96, 4096
  s_mov_b32 s97, 8192
  s_mov_b32 s98, 12288
  s_mov_b32 s99, 16384
  s_mov_b32 s100, 20480
  s_mov_b32 s101, 24576
  s_mov_b32 s3, 28672
  s_mov_b32 s60, 32768
  v_mov_b32 v8, v16
  v_add_u32 v240, 144, v9
  v_min_u32 v240, 195, v240
  v_mul_u32_u24 v4, 1338, v240
  v_lshrrev_b32 v4, 16, v4
  v_mad_i32_i24 v5, v4, s24, v240
  v_mul_u32_u24 v5, 9363, v5
  v_lshrrev_b32 v5, 16, v5
  v_mad_u32_u24 v10, v240, s23, v8
  v_mad_i32_i24 v10, v4, s25, v10
  v_mad_u32_u24 v10, v5, s26, v10
  s_add_u32 s27, s21, 22
  s_min_u32 s27, s27, 24
  s_mul_i32 s37, s27, 3072
  s_lshl_b32 s67, s27, 3
  s_bitcmp1_b32 s27, 0
  s_cselect_b64 vcc, -1, 0
  v_cndmask_b32 v7, v44, v45, vcc
  v_lshrrev_b32 v240, 3, v1
  v_add_u32 v240, s67, v240
  v_min_u32 v240, 195, v240
  v_mul_u32_u24 v4, 1338, v240
  v_lshrrev_b32 v4, 16, v4
  v_mad_i32_i24 v5, v4, s24, v240
  v_mul_u32_u24 v5, 9363, v5
  v_lshrrev_b32 v5, 16, v5
  v_mad_u32_u24 v11, v240, s23, v7
  v_mad_i32_i24 v11, v4, s25, v11
  v_mad_u32_u24 v11, v5, s26, v11
  v_add_u32 v20, 61440, v18
  v_add_u32 v21, 61440, v19
  v_lshrrev_b32 v7, 4, v242
  v_xor_b32 v7, v3, v7
  v_add_u32 v4, v242, v7
  v_xor_b32 v5, 4, v7
  v_add_u32 v5, v242, v5
  v_lshlrev_b32 v4, 4, v4
  v_lshlrev_b32 v5, 4, v5
  v_add_u32 v22, 73728, v4
  v_add_u32 v23, 73728, v5
  s_mov_b32 s12, s50
  s_and_b32 s13, s51, 0xffff
  s_mov_b32 s14, 19267584
  s_mov_b32 s15, 0x00020000
  v_add_u32 v27, 76800, v255
  v_lshl_add_u32 v24, v6, 10, v27
  v_lshrrev_b32 v5, 1, v6
  v_lshl_add_u32 v25, v5, 10, v27
  v_and_b32 v5, 1, v6
  v_lshl_add_u32 v25, v5, 3, v25
  v_add_u32 v25, 4096, v25
  v_add_u32 v29, 125952, v255
  v_lshl_add_u32 v28, v6, 11, v29
  s_mov_b32 s36, 0xf149f2ca
  v_mov_b32 v4, s36
  v_cmp_eq_u32 vcc, 0, v3
  s_nop 1
  v_cndmask_b32 v30, 0, v4, vcc
  v_cndmask_b32_e64 v31, v4, 0, vcc
  v_cmp_le_u32_e64 s[28:29], 1, v2
  v_cmp_le_u32_e64 s[30:31], 2, v2
  v_cmp_le_u32_e64 s[32:33], 3, v2
  v_cmp_le_u32_e64 s[34:35], 4, v2
  v_mul_u32_u24 v47, 96, v6
  v_lshl_add_u32 v47, v3, 4, v47
  v_add_u32 v47, s20, v47
  v_lshlrev_b32 v4, 3, v3
  v_sub_u32 v45, 64, v4
  v_mov_b32 v46, 0x7f000000
  v_add_u32 v248, 144, v2
  v_min_u32 v248, 195, v248
  v_mul_u32_u24 v249, 1338, v248
  v_lshrrev_b32 v249, 16, v249
  v_mad_i32_i24 v250, v249, s24, v248
  v_mul_u32_u24 v250, 9363, v250
  v_lshrrev_b32 v250, 16, v250
  v_mad_u32_u24 v41, v248, s23, v47
  v_mad_i32_i24 v41, v249, s25, v41
  v_mad_u32_u24 v41, v250, s26, v41
  v_add_u32 v248, 160, v2
  v_min_u32 v248, 195, v248
  v_mul_u32_u24 v249, 1338, v248
  v_lshrrev_b32 v249, 16, v249
  v_mad_i32_i24 v250, v249, s24, v248
  v_mul_u32_u24 v250, 9363, v250
  v_lshrrev_b32 v250, 16, v250
  v_mad_u32_u24 v42, v248, s23, v47
  v_mad_i32_i24 v42, v249, s25, v42
  v_mad_u32_u24 v42, v250, s26, v42
  v_add_u32 v248, 176, v2
  v_min_u32 v248, 195, v248
  v_mul_u32_u24 v249, 1338, v248
  v_lshrrev_b32 v249, 16, v249
  v_mad_i32_i24 v250, v249, s24, v248
  v_mul_u32_u24 v250, 9363, v250
  v_lshrrev_b32 v250, 16, v250
  v_mad_u32_u24 v43, v248, s23, v47
  v_mad_i32_i24 v43, v249, s25, v43
  v_mad_u32_u24 v43, v250, s26, v43
  v_add_u32 v248, 192, v2
  v_min_u32 v248, 195, v248
  v_mul_u32_u24 v249, 1338, v248
  v_lshrrev_b32 v249, 16, v249
  v_mad_i32_i24 v250, v249, s24, v248
  v_mul_u32_u24 v250, 9363, v250
  v_lshrrev_b32 v250, 16, v250
  v_mad_u32_u24 v44, v248, s23, v47
  v_mad_i32_i24 v44, v249, s25, v44
  v_mad_u32_u24 v44, v250, s26, v44
  v_mul_u32_u24 v12, 400, v2
  v_mul_u32_u24 v248, 96, v6
  v_add_u32 v12, v12, v248
  v_lshl_add_u32 v12, v3, 4, v12
  v_add_u32 v13, v12, v45
  v_add_u32 v248, 0, v0
  v_mul_u32_u24 v249, 2731, v248
  v_lshrrev_b32 v249, 16, v249
  v_add_u32 v249, v249, v248
  v_lshlrev_b32 v32, 4, v249
  v_mul_u32_u24 v250, 1561, v248
  v_lshrrev_b32 v250, 18, v250
  v_lshl_add_u32 v249, v248, 4, s20
  v_mad_u32_u24 v37, v250, s26, v249
  v_add_u32 v248, 256, v0
  v_mul_u32_u24 v249, 2731, v248
  v_lshrrev_b32 v249, 16, v249
  v_add_u32 v249, v249, v248
  v_lshlrev_b32 v33, 4, v249
  v_mul_u32_u24 v250, 1561, v248
  v_lshrrev_b32 v250, 18, v250
  v_lshl_add_u32 v249, v248, 4, s20
  v_mad_u32_u24 v38, v250, s26, v249
  v_add_u32 v248, 512, v0
  v_mul_u32_u24 v249, 2731, v248
  v_lshrrev_b32 v249, 16, v249
  v_add_u32 v249, v249, v248
  v_lshlrev_b32 v34, 4, v249
  v_mul_u32_u24 v250, 1561, v248
  v_lshrrev_b32 v250, 18, v250
  v_lshl_add_u32 v249, v248, 4, s20
  v_mad_u32_u24 v39, v250, s26, v249
  v_add_u32 v248, 768, v0
  v_mul_u32_u24 v249, 2731, v248
  v_lshrrev_b32 v249, 16, v249
  v_add_u32 v249, v249, v248
  v_lshlrev_b32 v35, 4, v249
  v_mul_u32_u24 v250, 1561, v248
  v_lshrrev_b32 v250, 18, v250
  v_lshl_add_u32 v249, v248, 4, s20
  v_mad_u32_u24 v40, v250, s26, v249
  v_add_u32 v248, 1024, v0
  v_cmp_gt_u32 vcc, 1176, v248
  v_min_u32 v248, 1175, v248
  v_mul_u32_u24 v249, 2731, v248
  v_lshrrev_b32 v249, 16, v249
  v_add_u32 v249, v249, v248
  v_lshlrev_b32 v36, 4, v249
  v_mul_u32_u24 v250, 1561, v248
  v_lshrrev_b32 v250, 18, v250
  v_lshl_add_u32 v249, v248, 4, s20
  v_mad_u32_u24 v14, v250, s26, v249
  v_cndmask_b32 v14, v46, v14, vcc
  v_mov_b32 v16, 142336
  s_add_u32 s27, s21, 0
  s_and_b32 s27, s27, 7
  s_mul_i32 s27, s27, 6144
  v_add_u32 v26, s27, v27
  v_mov_b32 v4, 134144
L_common:
  s_waitcnt vmcnt(6)
  s_waitcnt lgkmcnt(0)
  s_barrier
L_segA:
  ds_read_b32 v5, v4 offset:0
  buffer_load_dwordx4 a[0:3], v17, s[8:11], 0 offen offset:0 sc1 nt
  buffer_load_dwordx4 a[24:27], v17, s[8:11], s96 offen offset:2048 sc1 nt
  buffer_load_dwordx4 a[48:51], v17, s[8:11], s98 offen offset:0 sc1 nt
  ds_read_b128 a[144:147], v18 offset:0
  ds_read_b128 a[168:171], v18 offset:6144
  ds_read_b128 a[192:195], v18 offset:12288
  ds_read_b128 a[216:219], v18 offset:18432
  ds_read_b128 a[240:243], v18 offset:24576
  ds_read_b128 a[248:251], v18 offset:30720
  ds_read_b128 a[148:151], v19 offset:0
  ds_read_b128 a[172:175], v19 offset:6144
  ds_read_b128 a[196:199], v19 offset:12288
  ds_read_b128 a[220:223], v19 offset:18432
  ds_read_b128 a[244:247], v19 offset:24576
  ds_read_b128 a[252:255], v19 offset:30720
  buffer_load_dwordx4 a[4:7], v17, s[8:11], 0 offen offset:1024 sc1 nt
  buffer_load_dwordx4 a[28:31], v17, s[8:11], s96 offen offset:3072 sc1 nt
  buffer_load_dwordx4 a[52:55], v17, s[8:11], s98 offen offset:1024 sc1 nt
  buffer_load_dword v243, v244, s[92:95], s40 offen offset:0 sc1
  buffer_load_dwordx4 a[8:11], v17, s[8:11], 0 offen offset:2048 sc1 nt
  buffer_load_dwordx4 a[32:35], v17, s[8:11], s97 offen offset:0 sc1 nt
  buffer_load_dwordx4 a[56:59], v17, s[8:11], s98 offen offset:2048 sc1 nt
  buffer_load_dwordx4 a[12:15], v17, s[8:11], 0 offen offset:3072 sc1 nt
  buffer_load_dwordx4 a[36:39], v17, s[8:11], s97 offen offset:1024 sc1 nt
  buffer_load_dwordx4 a[60:63], v17, s[8:11], s98 offen offset:3072 sc1 nt
  buffer_load_dwordx4 a[16:19], v17, s[8:11], s96 offen offset:0 sc1 nt
  buffer_load_dwordx4 a[40:43], v17, s[8:11], s97 offen offset:2048 sc1 nt
  buffer_load_dwordx4 a[64:67], v17, s[8:11], s99 offen offset:0 sc1 nt
  buffer_load_dwordx4 a[20:23], v17, s[8:11], s96 offen offset:1024 sc1 nt
  buffer_load_dwordx4 a[44:47], v17, s[8:11], s97 offen offset:3072 sc1 nt
  buffer_load_dwordx4 a[68:71], v17, s[8:11], s99 offen offset:1024 sc1 nt
  s_waitcnt lgkmcnt(12)
  v_readfirstlane_b32 s27, v5
  s_nop 0
  s_cmp_gt_u32 s27, s42
  s_cbranch_scc1 L_fallback
  s_waitcnt lgkmcnt(11) vmcnt(18)
  v_mfma_f32_16x16x32_bf16 v[96:99], a[0:3], a[144:147], 0
  ds_read_b128 a[152:155], v18 offset:1024
  ds_read_b128 a[176:179], v18 offset:7168
  s_waitcnt vmcnt(17)
  v_mfma_f32_16x16x32_bf16 v[100:103], a[24:27], a[144:147], 0
  ds_read_b128 a[200:203], v18 offset:13312
  ds_read_b128 a[224:227], v18 offset:19456
  s_waitcnt vmcnt(16)
  v_mfma_f32_16x16x32_bf16 v[104:107], a[48:51], a[144:147], 0
  s_waitcnt lgkmcnt(12)
  v_mfma_f32_16x16x32_bf16 v[108:111], a[0:3], a[168:171], 0
  v_mfma_f32_16x16x32_bf16 v[112:115], a[24:27], a[168:171], 0
  v_mfma_f32_16x16x32_bf16 v[116:119], a[48:51], a[168:171], 0
  v_mfma_f32_16x16x32_bf16 v[120:123], a[0:3], a[192:195], 0
  v_mfma_f32_16x16x32_bf16 v[124:127], a[24:27], a[192:195], 0
  v_mfma_f32_16x16x32_bf16 v[128:131], a[48:51], a[192:195], 0
  v_mfma_f32_16x16x32_bf16 v[132:135], a[0:3], a[216:219], 0
  v_mfma_f32_16x16x32_bf16 v[136:139], a[24:27], a[216:219], 0
  v_mfma_f32_16x16x32_bf16 v[140:143], a[48:51], a[216:219], 0
  s_waitcnt lgkmcnt(4)
  v_mfma_f32_16x16x32_bf16 v[144:147], a[0:3], a[240:243], 0
  v_mfma_f32_16x16x32_bf16 v[148:151], a[24:27], a[240:243], 0
  v_mfma_f32_16x16x32_bf16 v[152:155], a[48:51], a[240:243], 0
  ds_read_b128 a[240:243], v18 offset:25600
  v_mfma_f32_16x16x32_bf16 v[156:159], a[0:3], a[248:251], 0
  v_mfma_f32_16x16x32_bf16 v[160:163], a[24:27], a[248:251], 0
  v_mfma_f32_16x16x32_bf16 v[164:167], a[48:51], a[248:251], 0
  ds_read_b128 a[248:251], v18 offset:31744
  ds_read_b128 a[156:159], v19 offset:1024
  s_waitcnt vmcnt(15)
  v_mfma_f32_16x16x32_bf16 v[96:99], a[4:7], a[148:151], v[96:99]
  ds_read_b128 a[180:183], v19 offset:7168
  ds_read_b128 a[204:207], v19 offset:13312
  s_waitcnt vmcnt(14)
  v_mfma_f32_16x16x32_bf16 v[100:103], a[28:31], a[148:151], v[100:103]
  ds_read_b128 a[228:231], v19 offset:19456
  s_waitcnt vmcnt(13)
  v_mfma_f32_16x16x32_bf16 v[104:107], a[52:55], a[148:151], v[104:107]
  v_mfma_f32_16x16x32_bf16 v[108:111], a[4:7], a[172:175], v[108:111]
  v_mfma_f32_16x16x32_bf16 v[112:115], a[28:31], a[172:175], v[112:115]
  v_mfma_f32_16x16x32_bf16 v[116:119], a[52:55], a[172:175], v[116:119]
  v_mfma_f32_16x16x32_bf16 v[120:123], a[4:7], a[196:199], v[120:123]
  v_mfma_f32_16x16x32_bf16 v[124:127], a[28:31], a[196:199], v[124:127]
  v_mfma_f32_16x16x32_bf16 v[128:131], a[52:55], a[196:199], v[128:131]
  v_mfma_f32_16x16x32_bf16 v[132:135], a[4:7], a[220:223], v[132:135]
  v_mfma_f32_16x16x32_bf16 v[136:139], a[28:31], a[220:223], v[136:139]
  v_mfma_f32_16x16x32_bf16 v[140:143], a[52:55], a[220:223], v[140:143]
  v_mfma_f32_16x16x32_bf16 v[144:147], a[4:7], a[244:247], v[144:147]
  v_mfma_f32_16x16x32_bf16 v[148:151], a[28:31], a[244:247], v[148:151]
  v_mfma_f32_16x16x32_bf16 v[152:155], a[52:55], a[244:247], v[152:155]
  ds_read_b128 a[244:247], v19 offset:25600
  v_mfma_f32_16x16x32_bf16 v[156:159], a[4:7], a[252:255], v[156:159]
  v_mfma_f32_16x16x32_bf16 v[160:163], a[28:31], a[252:255], v[160:163]
  v_mfma_f32_16x16x32_bf16 v[164:167], a[52:55], a[252:255], v[164:167]
  ds_read_b128 a[252:255], v19 offset:31744
  ds_read_b128 a[160:163], v18 offset:2048
  s_waitcnt vmcnt(12)
  v_and_b32 v247, v243, v246
  v_cmp_ne_u32 vcc, v247, v246
  s_nop 1
  s_cmp_lg_u64 vcc, 0
  s_cbranch_scc1 L_nslow
L_polln_ok:
  s_waitcnt lgkmcnt(9) vmcnt(11)
  v_mfma_f32_16x16x32_bf16 v[96:99], a[8:11], a[152:155], v[96:99]
  ds_read_b128 a[184:187], v18 offset:8192
  ds_read_b128 a[208:211], v18 offset:14336
  s_waitcnt vmcnt(10)
  v_mfma_f32_16x16x32_bf16 v[100:103], a[32:35], a[152:155], v[100:103]
  ds_read_b128 a[232:235], v18 offset:20480
  buffer_load_dwordx4 a[72:75], v17, s[8:11], s99 offen offset:2048 sc1 nt
  s_waitcnt vmcnt(10)
  v_mfma_f32_16x16x32_bf16 v[104:107], a[56:59], a[152:155], v[104:107]
  s_mov_b32 s62, 2688
  s_mov_b32 s63, 5376
  v_mfma_f32_16x16x32_bf16 v[108:111], a[8:11], a[176:179], v[108:111]
  s_mov_b32 s64, 8064
  v_mov_b32 v248, v31
  v_mfma_f32_16x16x32_bf16 v[112:115], a[32:35], a[176:179], v[112:115]
  v_mov_b32 v249, v31
  v_mov_b32 v250, v31
  v_mfma_f32_16x16x32_bf16 v[116:119], a[56:59], a[176:179], v[116:119]
  v_mov_b32 v251, v31
  v_mov_b32 v244, 0
  v_mfma_f32_16x16x32_bf16 v[120:123], a[8:11], a[200:203], v[120:123]
  v_mov_b32 v245, 0
  v_mov_b32 v246, 0
  v_mfma_f32_16x16x32_bf16 v[124:127], a[32:35], a[200:203], v[124:127]
  v_mov_b32 v247, 0
  buffer_load_dwordx4 a[96:99], v17, s[8:11], s101 offen offset:0 sc1 nt
  v_mfma_f32_16x16x32_bf16 v[128:131], a[56:59], a[200:203], v[128:131]
  v_mfma_f32_16x16x32_bf16 v[132:135], a[8:11], a[224:227], v[132:135]
  v_mfma_f32_16x16x32_bf16 v[136:139], a[32:35], a[224:227], v[136:139]
  v_mfma_f32_16x16x32_bf16 v[140:143], a[56:59], a[224:227], v[140:143]
  s_waitcnt lgkmcnt(5)
  v_mfma_f32_16x16x32_bf16 v[144:147], a[8:11], a[240:243], v[144:147]
  buffer_load_dwordx4 a[120:123], v17, s[8:11], s3 offen offset:2048 sc1 nt
  v_mfma_f32_16x16x32_bf16 v[148:151], a[32:35], a[240:243], v[148:151]
  v_mfma_f32_16x16x32_bf16 v[152:155], a[56:59], a[240:243], v[152:155]
  ds_read_b128 a[240:243], v18 offset:26624
  v_mfma_f32_16x16x32_bf16 v[156:159], a[8:11], a[248:251], v[156:159]
  v_mfma_f32_16x16x32_bf16 v[160:163], a[32:35], a[248:251], v[160:163]
  v_mfma_f32_16x16x32_bf16 v[164:167], a[56:59], a[248:251], v[164:167]
  ds_read_b128 a[248:251], v18 offset:32768
  ds_read_b128 a[164:167], v19 offset:2048
  s_waitcnt vmcnt(11)
  v_mfma_f32_16x16x32_bf16 v[96:99], a[12:15], a[156:159], v[96:99]
  ds_read_b128 a[188:191], v19 offset:8192
  ds_read_b128 a[212:215], v19 offset:14336
  s_waitcnt vmcnt(10)
  v_mfma_f32_16x16x32_bf16 v[100:103], a[36:39], a[156:159], v[100:103]
  ds_read_b128 a[236:239], v19 offset:20480
  buffer_load_dwordx4 a[76:79], v17, s[8:11], s99 offen offset:3072 sc1 nt
  s_waitcnt vmcnt(10)
  v_mfma_f32_16x16x32_bf16 v[104:107], a[60:63], a[156:159], v[104:107]
  v_mfma_f32_16x16x32_bf16 v[108:111], a[12:15], a[180:183], v[108:111]
  v_mfma_f32_16x16x32_bf16 v[112:115], a[36:39], a[180:183], v[112:115]
  v_mfma_f32_16x16x32_bf16 v[116:119], a[60:63], a[180:183], v[116:119]
  v_mfma_f32_16x16x32_bf16 v[120:123], a[12:15], a[204:207], v[120:123]
  buffer_load_dwordx4 a[100:103], v17, s[8:11], s101 offen offset:1024 sc1 nt
  v_mfma_f32_16x16x32_bf16 v[124:127], a[36:39], a[204:207], v[124:127]
  v_mfma_f32_16x16x32_bf16 v[128:131], a[60:63], a[204:207], v[128:131]
  v_mfma_f32_16x16x32_bf16 v[132:135], a[12:15], a[228:231], v[132:135]
  v_mfma_f32_16x16x32_bf16 v[136:139], a[36:39], a[228:231], v[136:139]
  v_mfma_f32_16x16x32_bf16 v[140:143], a[60:63], a[228:231], v[140:143]
  v_mfma_f32_16x16x32_bf16 v[144:147], a[12:15], a[244:247], v[144:147]
  buffer_load_dwordx4 a[124:127], v17, s[8:11], s3 offen offset:3072 sc1 nt
  v_mfma_f32_16x16x32_bf16 v[148:151], a[36:39], a[244:247], v[148:151]
  v_mfma_f32_16x16x32_bf16 v[152:155], a[60:63], a[244:247], v[152:155]
  ds_read_b128 a[244:247], v19 offset:26624
  s_waitcnt lgkmcnt(7)
  v_mfma_f32_16x16x32_bf16 v[156:159], a[12:15], a[252:255], v[156:159]
  v_mfma_f32_16x16x32_bf16 v[160:163], a[36:39], a[252:255], v[160:163]
  v_mfma_f32_16x16x32_bf16 v[164:167], a[60:63], a[252:255], v[164:167]
  ds_read_b128 a[252:255], v19 offset:32768
  s_waitcnt vmcnt(11)
  v_mfma_f32_16x16x32_bf16 v[96:99], a[16:19], a[160:163], v[96:99]
  buffer_load_dwordx4 a[80:83], v17, s[8:11], s100 offen offset:0 sc1 nt
  s_waitcnt vmcnt(11)
  v_mfma_f32_16x16x32_bf16 v[100:103], a[40:43], a[160:163], v[100:103]
  s_waitcnt vmcnt(10)
  v_mfma_f32_16x16x32_bf16 v[104:107], a[64:67], a[160:163], v[104:107]
  v_mfma_f32_16x16x32_bf16 v[108:111], a[16:19], a[184:187], v[108:111]
  v_mfma_f32_16x16x32_bf16 v[112:115], a[40:43], a[184:187], v[112:115]
  v_mfma_f32_16x16x32_bf16 v[116:119], a[64:67], a[184:187], v[116:119]
  v_mfma_f32_16x16x32_bf16 v[120:123], a[16:19], a[208:211], v[120:123]
  buffer_load_dwordx4 a[104:107], v17, s[8:11], s101 offen offset:2048 sc1 nt
  v_mfma_f32_16x16x32_bf16 v[124:127], a[40:43], a[208:211], v[124:127]
  v_mfma_f32_16x16x32_bf16 v[128:131], a[64:67], a[208:211], v[128:131]
  v_mfma_f32_16x16x32_bf16 v[132:135], a[16:19], a[232:235], v[132:135]
  v_mfma_f32_16x16x32_bf16 v[136:139], a[40:43], a[232:235], v[136:139]
  v_mfma_f32_16x16x32_bf16 v[140:143], a[64:67], a[232:235], v[140:143]
  s_waitcnt lgkmcnt(2)
  v_mfma_f32_16x16x32_bf16 v[144:147], a[16:19], a[240:243], v[144:147]
  buffer_load_dwordx4 a[128:131], v17, s[8:11], s60 offen offset:0 sc1 nt
  v_mfma_f32_16x16x32_bf16 v[148:151], a[40:43], a[240:243], v[148:151]
  v_mfma_f32_16x16x32_bf16 v[152:155], a[64:67], a[240:243], v[152:155]
  v_mfma_f32_16x16x32_bf16 v[156:159], a[16:19], a[248:251], v[156:159]
  v_mfma_f32_16x16x32_bf16 v[160:163], a[40:43], a[248:251], v[160:163]
  v_mfma_f32_16x16x32_bf16 v[164:167], a[64:67], a[248:251], v[164:167]
  s_waitcnt vmcnt(11)
  v_mfma_f32_16x16x32_bf16 v[96:99], a[20:23], a[164:167], v[96:99]
  buffer_load_dwordx4 a[84:87], v17, s[8:11], s100 offen offset:1024 sc1 nt
  s_waitcnt vmcnt(11)
  v_mfma_f32_16x16x32_bf16 v[100:103], a[44:47], a[164:167], v[100:103]
  s_waitcnt vmcnt(10)
  v_mfma_f32_16x16x32_bf16 v[104:107], a[68:71], a[164:167], v[104:107]
  v_mfma_f32_16x16x32_bf16 v[108:111], a[20:23], a[188:191], v[108:111]
  v_mfma_f32_16x16x32_bf16 v[112:115], a[44:47], a[188:191], v[112:115]
  v_mfma_f32_16x16x32_bf16 v[116:119], a[68:71], a[188:191], v[116:119]
  v_mfma_f32_16x16x32_bf16 v[120:123], a[20:23], a[212:215], v[120:123]
  v_cvt_pk_bf16_f32 v96, v96, v97
  v_cvt_pk_bf16_f32 v97, v98, v99
  v_mfma_f32_16x16x32_bf16 v[124:127], a[44:47], a[212:215], v[124:127]
  v_cvt_pk_bf16_f32 v98, v100, v101
  v_cvt_pk_bf16_f32 v99, v102, v103
  buffer_load_dwordx4 a[108:111], v17, s[8:11], s101 offen offset:3072 sc1 nt
  v_mfma_f32_16x16x32_bf16 v[128:131], a[68:71], a[212:215], v[128:131]
  ds_write_b128 v24, v[96:99] offset:0
  v_cvt_pk_bf16_f32 v104, v104, v105
  v_mfma_f32_16x16x32_bf16 v[132:135], a[20:23], a[236:239], v[132:135]
  v_cvt_pk_bf16_f32 v105, v106, v107
  ds_write_b64 v25, v[104:105] offset:0
  v_mfma_f32_16x16x32_bf16 v[136:139], a[44:47], a[236:239], v[136:139]
  v_cvt_pk_bf16_f32 v108, v108, v109
  v_cvt_pk_bf16_f32 v109, v110, v111
  v_mfma_f32_16x16x32_bf16 v[140:143], a[68:71], a[236:239], v[140:143]
  v_cvt_pk_bf16_f32 v110, v112, v113
  v_cvt_pk_bf16_f32 v111, v114, v115
  s_waitcnt lgkmcnt(2)
  v_mfma_f32_16x16x32_bf16 v[144:147], a[20:23], a[244:247], v[144:147]
  ds_write_b128 v24, v[108:111] offset:6144
  v_cvt_pk_bf16_f32 v116, v116, v117
  v_mfma_f32_16x16x32_bf16 v[148:151], a[44:47], a[244:247], v[148:151]
  v_cvt_pk_bf16_f32 v117, v118, v119
  ds_write_b64 v25, v[116:117] offset:6144
  buffer_load_dwordx4 a[132:135], v17, s[8:11], s60 offen offset:1024 sc1 nt
  v_mfma_f32_16x16x32_bf16 v[152:155], a[68:71], a[244:247], v[152:155]
  v_cvt_pk_bf16_f32 v120, v120, v121
  v_cvt_pk_bf16_f32 v121, v122, v123
  v_mfma_f32_16x16x32_bf16 v[156:159], a[20:23], a[252:255], v[156:159]
  v_cvt_pk_bf16_f32 v122, v124, v125
  v_cvt_pk_bf16_f32 v123, v126, v127
  v_mfma_f32_16x16x32_bf16 v[160:163], a[44:47], a[252:255], v[160:163]
  ds_write_b128 v24, v[120:123] offset:12288
  v_cvt_pk_bf16_f32 v128, v128, v129
  v_mfma_f32_16x16x32_bf16 v[164:167], a[68:71], a[252:255], v[164:167]
  v_cvt_pk_bf16_f32 v129, v130, v131
  ds_write_b64 v25, v[128:129] offset:12288
  v_cvt_pk_bf16_f32 v132, v132, v133
  v_cvt_pk_bf16_f32 v133, v134, v135
  v_cvt_pk_bf16_f32 v134, v136, v137
  v_cvt_pk_bf16_f32 v135, v138, v139
  ds_write_b128 v24, v[132:135] offset:18432
  v_cvt_pk_bf16_f32 v140, v140, v141
  v_cvt_pk_bf16_f32 v141, v142, v143
  ds_write_b64 v25, v[140:141] offset:18432
  v_cvt_pk_bf16_f32 v144, v144, v145
  v_cvt_pk_bf16_f32 v145, v146, v147
  v_cvt_pk_bf16_f32 v146, v148, v149
  v_cvt_pk_bf16_f32 v147, v150, v151
  ds_write_b128 v24, v[144:147] offset:24576
  v_cvt_pk_bf16_f32 v152, v152, v153
  v_cvt_pk_bf16_f32 v153, v154, v155
  ds_write_b64 v25, v[152:153] offset:24576
  v_cvt_pk_bf16_f32 v156, v156, v157
  v_cvt_pk_bf16_f32 v157, v158, v159
  v_cvt_pk_bf16_f32 v158, v160, v161
  v_cvt_pk_bf16_f32 v159, v162, v163
  ds_write_b128 v24, v[156:159] offset:30720
  v_cvt_pk_bf16_f32 v164, v164, v165
  v_cvt_pk_bf16_f32 v165, v166, v167
  ds_write_b64 v25, v[164:165] offset:30720
  s_waitcnt lgkmcnt(0)
  s_barrier
  ds_read_b128 v[184:187], v26 offset:0
  s_waitcnt vmcnt(11)
  v_mfma_f32_16x16x32_bf16 v[96:99], a[144:147], a[72:75], 0
  ds_read_b128 v[188:191], v26 offset:1024
  ds_read_b128 v[192:195], v26 offset:2048
  s_waitcnt vmcnt(10)
  v_mfma_f32_16x16x32_bf16 v[100:103], a[144:147], a[96:99], 0
  ds_read_b128 v[196:199], v26 offset:3072
  ds_read_b128 v[200:203], v26 offset:4096
  buffer_load_dwordx4 a[88:91], v17, s[8:11], s100 offen offset:2048 sc1 nt
  s_waitcnt vmcnt(10)
  v_mfma_f32_16x16x32_bf16 v[104:107], a[144:147], a[120:123], 0
  ds_read_b128 v[204:207], v26 offset:5120
  v_mfma_f32_16x16x32_bf16 v[108:111], a[168:171], a[72:75], 0
  v_mfma_f32_16x16x32_bf16 v[112:115], a[168:171], a[96:99], 0
  v_mfma_f32_16x16x32_bf16 v[116:119], a[168:171], a[120:123], 0
  v_mfma_f32_16x16x32_bf16 v[120:123], a[192:195], a[72:75], 0
  buffer_load_dwordx4 a[112:115], v17, s[8:11], s3 offen offset:0 sc1 nt
  v_mfma_f32_16x16x32_bf16 v[124:127], a[192:195], a[96:99], 0
  v_mfma_f32_16x16x32_bf16 v[128:131], a[192:195], a[120:123], 0
  s_add_u32 s27, s21, 3
  s_and_b32 s27, s27, 7
  v_mfma_f32_16x16x32_bf16 v[132:135], a[216:219], a[72:75], 0
  s_mul_i32 s27, s27, 6144
  v_add_u32 v26, s27, v27
  v_mfma_f32_16x16x32_bf16 v[136:139], a[216:219], a[96:99], 0
  v_mfma_f32_16x16x32_bf16 v[140:143], a[216:219], a[120:123], 0
  s_waitcnt lgkmcnt(5)
  v_mfma_f32_16x16x32_bf16 v[172:175], a[168:171], v[184:187], 0
  buffer_load_dwordx4 a[136:139], v17, s[8:11], s60 offen offset:2048 sc1 nt
  v_mfma_f32_16x16x32_bf16 v[176:179], a[192:195], v[184:187], 0
  v_mfma_f32_16x16x32_bf16 v[168:171], a[144:147], v[184:187], 0
  v_mfma_f32_16x16x32_bf16 v[180:183], a[216:219], v[184:187], v[248:251]
  ds_read_b128 a[144:147], v18 offset:24576
  ds_read_b128 a[168:171], v18 offset:30720
  s_waitcnt lgkmcnt(6)
  v_mfma_f32_16x16x32_bf16 v[172:175], a[172:175], v[188:191], v[172:175]
  ds_read_b128 a[192:195], v18 offset:36864
  v_mfma_f32_16x16x32_bf16 v[176:179], a[196:199], v[188:191], v[176:179]
  v_mfma_f32_16x16x32_bf16 v[168:171], a[148:151], v[188:191], v[168:171]
  buffer_load_dwordx4 a[92:95], v17, s[8:11], s100 offen offset:3072 sc1 nt
  v_mfma_f32_16x16x32_bf16 v[180:183], a[220:223], v[188:191], v[180:183]
  s_waitcnt lgkmcnt(6)
  v_mfma_f32_16x16x32_bf16 v[172:175], a[176:179], v[192:195], v[172:175]
  v_mfma_f32_16x16x32_bf16 v[176:179], a[200:203], v[192:195], v[176:179]
  v_mfma_f32_16x16x32_bf16 v[168:171], a[152:155], v[192:195], v[168:171]
  v_mfma_f32_16x16x32_bf16 v[180:183], a[224:227], v[192:195], v[180:183]
  s_waitcnt lgkmcnt(5)
  v_mfma_f32_16x16x32_bf16 v[172:175], a[180:183], v[196:199], v[172:175]
  buffer_load_dwordx4 a[116:119], v17, s[8:11], s3 offen offset:1024 sc1 nt
  v_mfma_f32_16x16x32_bf16 v[176:179], a[204:207], v[196:199], v[176:179]
  v_mfma_f32_16x16x32_bf16 v[168:171], a[156:159], v[196:199], v[168:171]
  v_mfma_f32_16x16x32_bf16 v[180:183], a[228:231], v[196:199], v[180:183]
  s_waitcnt lgkmcnt(3)
  v_mfma_f32_16x16x32_bf16 v[172:175], a[184:187], v[200:203], v[172:175]
  v_mfma_f32_16x16x32_bf16 v[176:179], a[208:211], v[200:203], v[176:179]
  v_mfma_f32_16x16x32_bf16 v[168:171], a[160:163], v[200:203], v[168:171]
  buffer_load_dwordx4 a[140:143], v17, s[8:11], s60 offen offset:3072 sc1 nt
  v_mfma_f32_16x16x32_bf16 v[180:183], a[232:235], v[200:203], v[180:183]
  v_mfma_f32_16x16x32_bf16 v[172:175], a[188:191], v[204:207], v[172:175]
  v_mfma_f32_16x16x32_bf16 v[176:179], a[212:215], v[204:207], v[176:179]
  v_mfma_f32_16x16x32_bf16 v[168:171], a[164:167], v[204:207], v[168:171]
  v_mfma_f32_16x16x32_bf16 v[180:183], a[236:239], v[204:207], v[180:183]
  s_waitcnt vmcnt(14)
  v_mfma_f32_16x16x32_bf16 v[96:99], a[148:151], a[76:79], v[96:99]
  s_add_u32 m0, s22, 55296
  s_nop 0
  buffer_load_dwordx4 v10, s[4:7], 0 offen offset:0 nt lds
  s_waitcnt vmcnt(14)
  v_mfma_f32_16x16x32_bf16 v[100:103], a[148:151], a[100:103], v[100:103]
  s_waitcnt vmcnt(13)
  v_mfma_f32_16x16x32_bf16 v[104:107], a[148:151], a[124:127], v[104:107]
  ds_read_b128 a[148:151], v19 offset:24576
  v_mfma_f32_16x16x32_bf16 v[108:111], a[172:175], a[76:79], v[108:111]
  v_max3_f32 v240, v172, v173, v174
  v_max3_f32 v240, v240, v175, v176
  v_mfma_f32_16x16x32_bf16 v[112:115], a[172:175], a[100:103], v[112:115]
  v_max3_f32 v240, v240, v177, v178
  v_max3_f32 v240, v240, v179, v168
  v_mfma_f32_16x16x32_bf16 v[116:119], a[172:175], a[124:127], v[116:119]
  ds_read_b128 a[172:175], v19 offset:30720
  v_max3_f32 v240, v240, v169, v170
  v_mfma_f32_16x16x32_bf16 v[120:123], a[196:199], a[76:79], v[120:123]
  v_max3_f32 v240, v240, v171, v180
  v_mov_b32 v241, v240
  v_mfma_f32_16x16x32_bf16 v[124:127], a[196:199], a[100:103], v[124:127]
  s_nop 0
  v_permlane32_swap_b32 v240, v241
  v_max_f32 v240, v240, v241
  s_add_u32 m0, s22, 56192
  s_nop 0
  buffer_load_dwordx4 v10, s[4:7], 0 offen offset:128 nt lds
  v_mfma_f32_16x16x32_bf16 v[128:131], a[196:199], a[124:127], v[128:131]
  ds_read_b128 a[196:199], v19 offset:36864
  v_mov_b32 v241, v240
  v_mfma_f32_16x16x32_bf16 v[132:135], a[220:223], a[76:79], v[132:135]
  s_nop 0
  v_permlane16_swap_b32 v240, v241
  v_max_f32 v240, v240, v241
  v_mfma_f32_16x16x32_bf16 v[136:139], a[220:223], a[100:103], v[136:139]
  v_sub_f32 v168, v168, v240
  v_sub_f32 v169, v169, v240
  v_mfma_f32_16x16x32_bf16 v[140:143], a[220:223], a[124:127], v[140:143]
  v_sub_f32 v170, v170, v240
  v_sub_f32 v171, v171, v240
  s_waitcnt lgkmcnt(3)
  v_mfma_f32_16x16x32_bf16 v[144:147], a[144:147], a[72:75], 0
  v_sub_f32 v172, v172, v240
  v_sub_f32 v173, v173, v240
  v_mfma_f32_16x16x32_bf16 v[148:151], a[144:147], a[96:99], 0
  v_sub_f32 v174, v174, v240
  v_sub_f32 v175, v175, v240
  s_add_u32 m0, s22, 57088
  s_nop 0
  buffer_load_dwordx4 v10, s[4:7], 0 offen offset:256 nt lds
  v_mfma_f32_16x16x32_bf16 v[152:155], a[144:147], a[120:123], 0
  v_sub_f32 v176, v176, v240
  v_sub_f32 v177, v177, v240
  v_mfma_f32_16x16x32_bf16 v[156:159], a[168:171], a[72:75], 0
  v_sub_f32 v178, v178, v240
  v_sub_f32 v179, v179, v240
  v_mfma_f32_16x16x32_bf16 v[160:163], a[168:171], a[96:99], 0
  v_sub_f32 v180, v180, v240
  v_mfma_f32_16x16x32_bf16 v[164:167], a[168:171], a[120:123], 0
  v_exp_f32 v168, v168
  s_waitcnt vmcnt(14)
  v_mfma_f32_16x16x32_bf16 v[96:99], a[152:155], a[80:83], v[96:99]
  v_exp_f32 v169, v169
  s_waitcnt vmcnt(13)
  v_mfma_f32_16x16x32_bf16 v[100:103], a[152:155], a[104:107], v[100:103]
  v_exp_f32 v170, v170
  s_add_u32 m0, s37, 0
  s_nop 0
  buffer_load_dwordx4 v11, s[4:7], 0 offen offset:0 nt lds
  s_waitcnt vmcnt(13)
  v_mfma_f32_16x16x32_bf16 v[104:107], a[152:155], a[128:131], v[104:107]
  ds_read_b128 a[152:155], v18 offset:25600
  v_mfma_f32_16x16x32_bf16 v[108:111], a[176:179], a[80:83], v[108:111]
  v_exp_f32 v171, v171
  v_mfma_f32_16x16x32_bf16 v[112:115], a[176:179], a[104:107], v[112:115]
  v_exp_f32 v172, v172
  v_mfma_f32_16x16x32_bf16 v[116:119], a[176:179], a[128:131], v[116:119]
  ds_read_b128 a[176:179], v18 offset:31744
  v_mfma_f32_16x16x32_bf16 v[120:123], a[200:203], a[80:83], v[120:123]
  v_exp_f32 v173, v173
  v_mfma_f32_16x16x32_bf16 v[124:127], a[200:203], a[104:107], v[124:127]
  v_exp_f32 v174, v174
  s_add_u32 m0, s37, 896
  s_nop 0
  buffer_load_dwordx4 v11, s[4:7], 0 offen offset:128 nt lds
  v_mfma_f32_16x16x32_bf16 v[128:131], a[200:203], a[128:131], v[128:131]
  ds_read_b128 a[200:203], v18 offset:37888
  v_mfma_f32_16x16x32_bf16 v[132:135], a[224:227], a[80:83], v[132:135]
  v_exp_f32 v175, v175
  v_mfma_f32_16x16x32_bf16 v[136:139], a[224:227], a[104:107], v[136:139]
  v_exp_f32 v176, v176
  v_mfma_f32_16x16x32_bf16 v[140:143], a[224:227], a[128:131], v[140:143]
  v_exp_f32 v177, v177
  s_waitcnt lgkmcnt(3)
  v_mfma_f32_16x16x32_bf16 v[144:147], a[148:151], a[76:79], v[144:147]
  v_exp_f32 v178, v178
  v_mfma_f32_16x16x32_bf16 v[148:151], a[148:151], a[100:103], v[148:151]
  v_exp_f32 v179, v179
  s_add_u32 m0, s37, 1792
  s_nop 0
  buffer_load_dwordx4 v11, s[4:7], 0 offen offset:256 nt lds
  v_mfma_f32_16x16x32_bf16 v[152:155], a[148:151], a[124:127], v[152:155]
  v_exp_f32 v180, v180
  v_mfma_f32_16x16x32_bf16 v[156:159], a[172:175], a[76:79], v[156:159]
  v_add_f32 v240, v168, v169
  v_add_f32 v240, v240, v170
  v_mfma_f32_16x16x32_bf16 v[160:163], a[172:175], a[100:103], v[160:163]
  v_add_f32 v240, v240, v171
  v_add_f32 v240, v240, v172
  v_mfma_f32_16x16x32_bf16 v[164:167], a[172:175], a[124:127], v[164:167]
  v_add_f32 v240, v240, v173
  v_add_f32 v240, v240, v174
  s_waitcnt vmcnt(14)
  v_mfma_f32_16x16x32_bf16 v[96:99], a[156:159], a[84:87], v[96:99]
  v_add_f32 v240, v240, v175
  v_add_f32 v240, v240, v176
  s_waitcnt vmcnt(13)
  v_mfma_f32_16x16x32_bf16 v[100:103], a[156:159], a[108:111], v[100:103]
  v_add_f32 v240, v240, v177
  v_add_f32 v240, v240, v178
  s_waitcnt vmcnt(12)
  v_mfma_f32_16x16x32_bf16 v[104:107], a[156:159], a[132:135], v[104:107]
  ds_read_b128 a[156:159], v19 offset:25600
  v_add_f32 v240, v240, v179
  v_mfma_f32_16x16x32_bf16 v[108:111], a[180:183], a[84:87], v[108:111]
  v_add_f32 v240, v240, v180
  v_mov_b32 v241, v240
  v_mfma_f32_16x16x32_bf16 v[112:115], a[180:183], a[108:111], v[112:115]
  s_nop 0
  v_permlane32_swap_b32 v240, v241
  v_add_f32 v240, v240, v241
  v_mfma_f32_16x16x32_bf16 v[116:119], a[180:183], a[132:135], v[116:119]
  ds_read_b128 a[180:183], v19 offset:31744
  v_mov_b32 v241, v240
  v_mfma_f32_16x16x32_bf16 v[120:123], a[204:207], a[84:87], v[120:123]
  s_nop 0
  v_permlane16_swap_b32 v240, v241
  v_add_f32 v240, v240, v241
  v_mfma_f32_16x16x32_bf16 v[124:127], a[204:207], a[108:111], v[124:127]
  v_rcp_f32 v240, v240
  v_mfma_f32_16x16x32_bf16 v[128:131], a[204:207], a[132:135], v[128:131]
  ds_read_b128 a[204:207], v19 offset:37888
  v_mul_f32 v168, v168, v240
  v_mfma_f32_16x16x32_bf16 v[132:135], a[228:231], a[84:87], v[132:135]
  v_mul_f32 v169, v169, v240
  v_mul_f32 v170, v170, v240
  v_mfma_f32_16x16x32_bf16 v[136:139], a[228:231], a[108:111], v[136:139]
  v_mul_f32 v171, v171, v240
  v_mul_f32 v172, v172, v240
  v_mfma_f32_16x16x32_bf16 v[140:143], a[228:231], a[132:135], v[140:143]
  v_mul_f32 v173, v173, v240
  v_mul_f32 v174, v174, v240
  s_waitcnt lgkmcnt(3)
  v_mfma_f32_16x16x32_bf16 v[144:147], a[152:155], a[80:83], v[144:147]
  v_mul_f32 v175, v175, v240
  v_cvt_pk_bf16_f32 v168, v168, v169
  v_mfma_f32_16x16x32_bf16 v[148:151], a[152:155], a[104:107], v[148:151]
  v_cvt_pk_bf16_f32 v169, v170, v171
  v_cvt_pk_bf16_f32 v170, v172, v173
  v_mfma_f32_16x16x32_bf16 v[152:155], a[152:155], a[128:131], v[152:155]
  v_cvt_pk_bf16_f32 v171, v174, v175
  ds_write_b128 v28, v[168:171] offset:0
  v_mfma_f32_16x16x32_bf16 v[156:159], a[176:179], a[80:83], v[156:159]
  v_mul_f32 v176, v176, v240
  v_mul_f32 v177, v177, v240
  v_mfma_f32_16x16x32_bf16 v[160:163], a[176:179], a[104:107], v[160:163]
  v_mul_f32 v178, v178, v240
  v_mul_f32 v179, v179, v240
  v_mfma_f32_16x16x32_bf16 v[164:167], a[176:179], a[128:131], v[164:167]
  v_mul_f32 v180, v180, v240
  v_cvt_pk_bf16_f32 v176, v176, v177
  s_waitcnt vmcnt(11)
  v_mfma_f32_16x16x32_bf16 v[96:99], a[160:163], a[88:91], v[96:99]
  v_cvt_pk_bf16_f32 v177, v178, v179
  v_cvt_pk_bf16_f32 v178, v180, 0
  s_waitcnt vmcnt(10)
  v_mfma_f32_16x16x32_bf16 v[100:103], a[160:163], a[112:115], v[100:103]
  v_cvt_pk_bf16_f32 v179, 0, 0
  ds_write_b128 v28, v[176:179] offset:1024
  s_waitcnt vmcnt(9)
  v_mfma_f32_16x16x32_bf16 v[104:107], a[160:163], a[136:139], v[104:107]
  ds_read_b128 a[160:163], v18 offset:26624
  v_mfma_f32_16x16x32_bf16 v[108:111], a[184:187], a[88:91], v[108:111]
  v_mfma_f32_16x16x32_bf16 v[112:115], a[184:187], a[112:115], v[112:115]
  v_mfma_f32_16x16x32_bf16 v[116:119], a[184:187], a[136:139], v[116:119]
  ds_read_b128 a[184:187], v18 offset:32768
  v_mfma_f32_16x16x32_bf16 v[120:123], a[208:211], a[88:91], v[120:123]
  v_mfma_f32_16x16x32_bf16 v[124:127], a[208:211], a[112:115], v[124:127]
  v_mfma_f32_16x16x32_bf16 v[128:131], a[208:211], a[136:139], v[128:131]
  ds_read_b128 a[208:211], v18 offset:38912
  v_mfma_f32_16x16x32_bf16 v[132:135], a[232:235], a[88:91], v[132:135]
  v_mfma_f32_16x16x32_bf16 v[136:139], a[232:235], a[112:115], v[136:139]
  v_mfma_f32_16x16x32_bf16 v[140:143], a[232:235], a[136:139], v[140:143]
  s_waitcnt lgkmcnt(5)
  v_mfma_f32_16x16x32_bf16 v[144:147], a[156:159], a[84:87], v[144:147]
  v_mfma_f32_16x16x32_bf16 v[148:151], a[156:159], a[108:111], v[148:151]
  v_mfma_f32_16x16x32_bf16 v[152:155], a[156:159], a[132:135], v[152:155]
  v_mfma_f32_16x16x32_bf16 v[156:159], a[180:183], a[84:87], v[156:159]
  v_mfma_f32_16x16x32_bf16 v[160:163], a[180:183], a[108:111], v[160:163]
  v_mfma_f32_16x16x32_bf16 v[164:167], a[180:183], a[132:135], v[164:167]
  s_waitcnt vmcnt(8)
  v_mfma_f32_16x16x32_bf16 v[96:99], a[164:167], a[92:95], v[96:99]
  s_waitcnt vmcnt(7)
  v_mfma_f32_16x16x32_bf16 v[100:103], a[164:167], a[116:119], v[100:103]
  s_waitcnt vmcnt(6)
  v_mfma_f32_16x16x32_bf16 v[104:107], a[164:167], a[140:143], v[104:107]
  ds_read_b128 a[164:167], v19 offset:26624
  v_mfma_f32_16x16x32_bf16 v[108:111], a[188:191], a[92:95], v[108:111]
  v_mfma_f32_16x16x32_bf16 v[112:115], a[188:191], a[116:119], v[112:115]
  v_mfma_f32_16x16x32_bf16 v[116:119], a[188:191], a[140:143], v[116:119]
  ds_read_b128 a[188:191], v19 offset:32768
  v_mfma_f32_16x16x32_bf16 v[120:123], a[212:215], a[92:95], v[120:123]
  v_cvt_pk_bf16_f32 v48, v96, v97
  v_cvt_pk_bf16_f32 v49, v98, v99
  v_mfma_f32_16x16x32_bf16 v[124:127], a[212:215], a[116:119], v[124:127]
  v_cvt_pk_bf16_f32 v64, v100, v101
  v_cvt_pk_bf16_f32 v65, v102, v103
  v_mfma_f32_16x16x32_bf16 v[128:131], a[212:215], a[140:143], v[128:131]
  ds_read_b128 a[212:215], v19 offset:38912
  v_cvt_pk_bf16_f32 v80, v104, v105
  v_mfma_f32_16x16x32_bf16 v[132:135], a[236:239], a[92:95], v[132:135]
  v_cvt_pk_bf16_f32 v81, v106, v107
  v_cvt_pk_bf16_f32 v50, v108, v109
  v_mfma_f32_16x16x32_bf16 v[136:139], a[236:239], a[116:119], v[136:139]
  v_cvt_pk_bf16_f32 v51, v110, v111
  v_cvt_pk_bf16_f32 v66, v112, v113
  v_mfma_f32_16x16x32_bf16 v[140:143], a[236:239], a[140:143], v[140:143]
  v_cvt_pk_bf16_f32 v67, v114, v115
  v_cvt_pk_bf16_f32 v82, v116, v117
  s_waitcnt lgkmcnt(3)
  v_mfma_f32_16x16x32_bf16 v[144:147], a[160:163], a[88:91], v[144:147]
  v_cvt_pk_bf16_f32 v83, v118, v119
  v_cvt_pk_bf16_f32 v52, v120, v121
  v_mfma_f32_16x16x32_bf16 v[148:151], a[160:163], a[112:115], v[148:151]
  v_cvt_pk_bf16_f32 v53, v122, v123
  v_cvt_pk_bf16_f32 v68, v124, v125
  v_mfma_f32_16x16x32_bf16 v[152:155], a[160:163], a[136:139], v[152:155]
  v_cvt_pk_bf16_f32 v69, v126, v127
  v_cvt_pk_bf16_f32 v84, v128, v129
  v_mfma_f32_16x16x32_bf16 v[156:159], a[184:187], a[88:91], v[156:159]
  v_cvt_pk_bf16_f32 v85, v130, v131
  v_cvt_pk_bf16_f32 v54, v132, v133
  v_mfma_f32_16x16x32_bf16 v[160:163], a[184:187], a[112:115], v[160:163]
  v_cvt_pk_bf16_f32 v55, v134, v135
  v_cvt_pk_bf16_f32 v70, v136, v137
  v_mfma_f32_16x16x32_bf16 v[164:167], a[184:187], a[136:139], v[164:167]
  v_cvt_pk_bf16_f32 v71, v138, v139
  v_cvt_pk_bf16_f32 v86, v140, v141
  v_mfma_f32_16x16x32_bf16 v[96:99], a[0:3], a[192:195], 0
  v_cvt_pk_bf16_f32 v87, v142, v143
  v_mfma_f32_16x16x32_bf16 v[100:103], a[24:27], a[192:195], 0
  v_mfma_f32_16x16x32_bf16 v[104:107], a[48:51], a[192:195], 0
  v_mfma_f32_16x16x32_bf16 v[96:99], a[4:7], a[196:199], v[96:99]
  v_mfma_f32_16x16x32_bf16 v[100:103], a[28:31], a[196:199], v[100:103]
  v_mfma_f32_16x16x32_bf16 v[104:107], a[52:55], a[196:199], v[104:107]
  v_mfma_f32_16x16x32_bf16 v[96:99], a[8:11], a[200:203], v[96:99]
  v_mfma_f32_16x16x32_bf16 v[100:103], a[32:35], a[200:203], v[100:103]
  v_mfma_f32_16x16x32_bf16 v[104:107], a[56:59], a[200:203], v[104:107]
  v_mfma_f32_16x16x32_bf16 v[96:99], a[12:15], a[204:207], v[96:99]
  v_mfma_f32_16x16x32_bf16 v[100:103], a[36:39], a[204:207], v[100:103]
  v_mfma_f32_16x16x32_bf16 v[104:107], a[60:63], a[204:207], v[104:107]
  v_mfma_f32_16x16x32_bf16 v[96:99], a[16:19], a[208:211], v[96:99]
  v_mfma_f32_16x16x32_bf16 v[100:103], a[40:43], a[208:211], v[100:103]
  v_mfma_f32_16x16x32_bf16 v[104:107], a[64:67], a[208:211], v[104:107]
  s_waitcnt lgkmcnt(0)
  v_mfma_f32_16x16x32_bf16 v[96:99], a[20:23], a[212:215], v[96:99]
  v_mfma_f32_16x16x32_bf16 v[100:103], a[44:47], a[212:215], v[100:103]
  v_mfma_f32_16x16x32_bf16 v[104:107], a[68:71], a[212:215], v[104:107]
  v_mfma_f32_16x16x32_bf16 v[144:147], a[164:167], a[92:95], v[144:147]
  v_mfma_f32_16x16x32_bf16 v[148:151], a[164:167], a[116:119], v[148:151]
  v_mfma_f32_16x16x32_bf16 v[152:155], a[164:167], a[140:143], v[152:155]
  v_mfma_f32_16x16x32_bf16 v[156:159], a[188:191], a[92:95], v[156:159]
  s_nop 1
  v_cvt_pk_bf16_f32 v96, v96, v97
  v_cvt_pk_bf16_f32 v97, v98, v99
  v_mfma_f32_16x16x32_bf16 v[160:163], a[188:191], a[116:119], v[160:163]
  v_cvt_pk_bf16_f32 v98, v100, v101
  v_cvt_pk_bf16_f32 v99, v102, v103
  v_mfma_f32_16x16x32_bf16 v[164:167], a[188:191], a[140:143], v[164:167]
  ds_write_b128 v24, v[96:99] offset:36864
  v_cvt_pk_bf16_f32 v104, v104, v105
  v_cvt_pk_bf16_f32 v105, v106, v107
  ds_write_b64 v25, v[104:105] offset:36864
  v_cvt_pk_bf16_f32 v56, v144, v145
  v_cvt_pk_bf16_f32 v57, v146, v147
  v_cvt_pk_bf16_f32 v72, v148, v149
  v_cvt_pk_bf16_f32 v73, v150, v151
  v_cvt_pk_bf16_f32 v88, v152, v153
  v_cvt_pk_bf16_f32 v89, v154, v155
  v_cvt_pk_bf16_f32 v58, v156, v157
  v_cvt_pk_bf16_f32 v59, v158, v159
  v_cvt_pk_bf16_f32 v74, v160, v161
  v_cvt_pk_bf16_f32 v75, v162, v163
  v_cvt_pk_bf16_f32 v90, v164, v165
  v_cvt_pk_bf16_f32 v91, v166, v167
  s_waitcnt vmcnt(3)
  s_waitcnt lgkmcnt(0)
  s_barrier
  v_mfma_f32_16x16x32_bf16 v[108:111], a[192:195], a[72:75], 0
  ds_read_b128 v[208:211], v29 offset:0
  ds_read_b128 v[212:215], v29 offset:1024
  v_mfma_f32_16x16x32_bf16 v[112:115], a[192:195], a[96:99], 0
  ds_read_b128 v[216:219], v29 offset:2048
  ds_read_b128 v[220:223], v29 offset:3072
  v_mfma_f32_16x16x32_bf16 v[116:119], a[192:195], a[120:123], 0
  ds_read_b128 v[224:227], v29 offset:4096
  ds_read_b128 v[228:231], v29 offset:5120
  v_mfma_f32_16x16x32_bf16 v[108:111], a[196:199], a[76:79], v[108:111]
  ds_read_b128 v[232:235], v29 offset:6144
  ds_read_b128 v[236:239], v29 offset:7168
  v_mfma_f32_16x16x32_bf16 v[112:115], a[196:199], a[100:103], v[112:115]
  ds_read_b128 v[184:187], v26 offset:0
  ds_read_b128 v[188:191], v26 offset:1024
  v_mfma_f32_16x16x32_bf16 v[116:119], a[196:199], a[124:127], v[116:119]
  ds_read_b128 v[192:195], v26 offset:2048
  ds_read_b128 v[196:199], v26 offset:3072
  v_mfma_f32_16x16x32_bf16 v[108:111], a[200:203], a[80:83], v[108:111]
  ds_read_b128 v[200:203], v26 offset:4096
  ds_read_b128 v[204:207], v26 offset:5120
  v_mfma_f32_16x16x32_bf16 v[112:115], a[200:203], a[104:107], v[112:115]
  v_mov_b32 v244, v30
  v_mfma_f32_16x16x32_bf16 v[116:119], a[200:203], a[128:131], v[116:119]
  s_waitcnt lgkmcnt(13)
  v_mfma_f32_16x16x32_bf16 v[120:123], v[48:51], v[208:211], 0
  v_mfma_f32_16x16x32_bf16 v[124:127], v[64:67], v[208:211], 0
  v_mfma_f32_16x16x32_bf16 v[128:131], v[80:83], v[208:211], 0
  s_waitcnt lgkmcnt(12)
  v_mfma_f32_16x16x32_bf16 v[120:123], v[52:55], v[212:215], v[120:123]
  v_mfma_f32_16x16x32_bf16 v[124:127], v[68:71], v[212:215], v[124:127]
  v_mfma_f32_16x16x32_bf16 v[128:131], v[84:87], v[212:215], v[128:131]
  s_waitcnt lgkmcnt(11)
  v_mfma_f32_16x16x32_bf16 v[132:135], v[48:51], v[216:219], 0
  v_mfma_f32_16x16x32_bf16 v[136:139], v[64:67], v[216:219], 0
  v_mfma_f32_16x16x32_bf16 v[140:143], v[80:83], v[216:219], 0
  s_waitcnt lgkmcnt(10)
  v_mfma_f32_16x16x32_bf16 v[132:135], v[52:55], v[220:223], v[132:135]
  v_cvt_pk_bf16_f32 v120, v120, v121
  v_cvt_pk_bf16_f32 v121, v122, v123
  v_mfma_f32_16x16x32_bf16 v[136:139], v[68:71], v[220:223], v[136:139]
  v_cvt_pk_bf16_f32 v122, v124, v125
  v_cvt_pk_bf16_f32 v123, v126, v127
  v_mfma_f32_16x16x32_bf16 v[140:143], v[84:87], v[220:223], v[140:143]
  ds_write_b128 v12, v[120:123] offset:0
  v_cvt_pk_bf16_f32 v128, v128, v129
  s_waitcnt lgkmcnt(10)
  v_mfma_f32_16x16x32_bf16 v[144:147], v[48:51], v[224:227], 0
  v_cvt_pk_bf16_f32 v129, v130, v131
  ds_write_b64 v13, v[128:129] offset:0
  v_mfma_f32_16x16x32_bf16 v[148:151], v[64:67], v[224:227], 0
  v_mfma_f32_16x16x32_bf16 v[152:155], v[80:83], v[224:227], 0
  s_waitcnt lgkmcnt(8)
  v_mfma_f32_16x16x32_bf16 v[144:147], v[52:55], v[228:231], v[144:147]
  v_cvt_pk_bf16_f32 v132, v132, v133
  v_cvt_pk_bf16_f32 v133, v134, v135
  v_mfma_f32_16x16x32_bf16 v[148:151], v[68:71], v[228:231], v[148:151]
  v_cvt_pk_bf16_f32 v134, v136, v137
  v_cvt_pk_bf16_f32 v135, v138, v139
  v_mfma_f32_16x16x32_bf16 v[152:155], v[84:87], v[228:231], v[152:155]
  ds_write_b128 v12, v[132:135] offset:6400
  v_cvt_pk_bf16_f32 v140, v140, v141
  v_mfma_f32_16x16x32_bf16 v[156:159], v[48:51], v[232:235], 0
  v_cvt_pk_bf16_f32 v141, v142, v143
  ds_write_b64 v13, v[140:141] offset:6400
  v_mfma_f32_16x16x32_bf16 v[160:163], v[64:67], v[232:235], 0
  v_mfma_f32_16x16x32_bf16 v[164:167], v[80:83], v[232:235], 0
  v_mfma_f32_16x16x32_bf16 v[156:159], v[52:55], v[236:239], v[156:159]
  v_cvt_pk_bf16_f32 v144, v144, v145
  v_cvt_pk_bf16_f32 v145, v146, v147
  v_mfma_f32_16x16x32_bf16 v[160:163], v[68:71], v[236:239], v[160:163]
  v_cvt_pk_bf16_f32 v146, v148, v149
  v_cvt_pk_bf16_f32 v147, v150, v151
  v_mfma_f32_16x16x32_bf16 v[164:167], v[84:87], v[236:239], v[164:167]
  ds_write_b128 v12, v[144:147] offset:12800
  v_cvt_pk_bf16_f32 v152, v152, v153
  s_waitcnt lgkmcnt(5)
  v_mfma_f32_16x16x32_bf16 v[172:175], a[144:147], v[184:187], 0
  v_cvt_pk_bf16_f32 v153, v154, v155
  ds_write_b64 v13, v[152:153] offset:12800
  v_mfma_f32_16x16x32_bf16 v[176:179], a[168:171], v[184:187], 0
  v_mfma_f32_16x16x32_bf16 v[168:171], a[216:219], v[184:187], v[244:247]
  v_mfma_f32_16x16x32_bf16 v[180:183], a[192:195], v[184:187], v[248:251]
  v_cvt_pk_bf16_f32 v156, v156, v157
  v_cvt_pk_bf16_f32 v157, v158, v159
  v_mfma_f32_16x16x32_bf16 v[172:175], a[148:151], v[188:191], v[172:175]
  v_cvt_pk_bf16_f32 v158, v160, v161
  v_cvt_pk_bf16_f32 v159, v162, v163
  v_mfma_f32_16x16x32_bf16 v[176:179], a[172:175], v[188:191], v[176:179]
  ds_write_b128 v12, v[156:159] offset:19200
  v_cvt_pk_bf16_f32 v164, v164, v165
  v_mfma_f32_16x16x32_bf16 v[168:171], a[220:223], v[188:191], v[168:171]
  v_cvt_pk_bf16_f32 v165, v166, v167
  ds_write_b64 v13, v[164:165] offset:19200
  v_mfma_f32_16x16x32_bf16 v[180:183], a[196:199], v[188:191], v[180:183]
  s_add_u32 s27, s21, 6
  s_and_b32 s27, s27, 7
  v_mfma_f32_16x16x32_bf16 v[172:175], a[152:155], v[192:195], v[172:175]
  s_mul_i32 s27, s27, 6144
  v_add_u32 v26, s27, v27
  v_mfma_f32_16x16x32_bf16 v[176:179], a[176:179], v[192:195], v[176:179]
  v_mfma_f32_16x16x32_bf16 v[168:171], a[224:227], v[192:195], v[168:171]
  v_mfma_f32_16x16x32_bf16 v[180:183], a[200:203], v[192:195], v[180:183]
  v_mfma_f32_16x16x32_bf16 v[172:175], a[156:159], v[196:199], v[172:175]
  v_mfma_f32_16x16x32_bf16 v[176:179], a[180:183], v[196:199], v[176:179]
  v_mfma_f32_16x16x32_bf16 v[168:171], a[228:231], v[196:199], v[168:171]
  s_waitcnt lgkmcnt(0)
  s_barrier
  v_mfma_f32_16x16x32_bf16 v[180:183], a[204:207], v[196:199], v[180:183]
  ds_read_b128 a[240:243], v32 offset:0
  v_mfma_f32_16x16x32_bf16 v[172:175], a[160:163], v[200:203], v[172:175]
  v_mfma_f32_16x16x32_bf16 v[176:179], a[184:187], v[200:203], v[176:179]
  v_mfma_f32_16x16x32_bf16 v[168:171], a[232:235], v[200:203], v[168:171]
  v_mfma_f32_16x16x32_bf16 v[180:183], a[208:211], v[200:203], v[180:183]
  v_mfma_f32_16x16x32_bf16 v[172:175], a[164:167], v[204:207], v[172:175]
  v_mfma_f32_16x16x32_bf16 v[176:179], a[188:191], v[204:207], v[176:179]
  v_mfma_f32_16x16x32_bf16 v[168:171], a[236:239], v[204:207], v[168:171]
  s_waitcnt lgkmcnt(0)
  buffer_store_dwordx4 a[240:243], v37, s[12:15], 0 offen offset:0 sc1
  v_mfma_f32_16x16x32_bf16 v[180:183], a[212:215], v[204:207], v[180:183]
  v_mfma_f32_16x16x32_bf16 v[108:111], a[204:207], a[84:87], v[108:111]
  ds_read_b128 a[216:219], v18 offset:43008
  v_mfma_f32_16x16x32_bf16 v[112:115], a[204:207], a[108:111], v[112:115]
  ds_read_b128 a[220:223], v19 offset:43008
  v_mfma_f32_16x16x32_bf16 v[116:119], a[204:207], a[132:135], v[116:119]
  ds_read_b128 a[224:227], v18 offset:44032
  v_mfma_f32_16x16x32_bf16 v[108:111], a[208:211], a[88:91], v[108:111]
  ds_read_b128 a[228:231], v19 offset:44032
  v_max3_f32 v240, v172, v173, v174
  v_mfma_f32_16x16x32_bf16 v[112:115], a[208:211], a[112:115], v[112:115]
  ds_read_b128 a[232:235], v18 offset:45056
  v_max3_f32 v240, v240, v175, v176
  v_mfma_f32_16x16x32_bf16 v[116:119], a[208:211], a[136:139], v[116:119]
  ds_read_b128 a[236:239], v19 offset:45056
  v_max3_f32 v240, v240, v177, v178
  v_mfma_f32_16x16x32_bf16 v[108:111], a[212:215], a[92:95], v[108:111]
  ds_read_b128 a[144:147], v18 offset:49152
  v_max3_f32 v240, v240, v179, v168
  v_mfma_f32_16x16x32_bf16 v[112:115], a[212:215], a[116:119], v[112:115]
  ds_read_b128 a[148:151], v19 offset:49152
  v_max3_f32 v240, v240, v169, v170
  v_mfma_f32_16x16x32_bf16 v[116:119], a[212:215], a[140:143], v[116:119]
  ds_read_b128 a[152:155], v18 offset:50176
  v_max3_f32 v240, v240, v171, v180
  s_waitcnt lgkmcnt(8)
  v_mfma_f32_16x16x32_bf16 v[96:99], a[0:3], a[216:219], 0
  ds_read_b128 a[156:159], v19 offset:50176
  v_max_f32 v240, v240, v181
  v_mfma_f32_16x16x32_bf16 v[100:103], a[24:27], a[216:219], 0
  ds_read_b128 a[160:163], v18 offset:51200
  v_mov_b32 v241, v240
  v_mfma_f32_16x16x32_bf16 v[104:107], a[48:51], a[216:219], 0
  ds_read_b128 a[244:247], v33 offset:0
  ds_read_b128 a[164:167], v19 offset:51200
  s_waitcnt lgkmcnt(11)
  v_mfma_f32_16x16x32_bf16 v[96:99], a[4:7], a[220:223], v[96:99]
  ds_read_b128 a[168:171], v18 offset:55296
  v_cvt_pk_bf16_f32 v60, v108, v109
  v_mfma_f32_16x16x32_bf16 v[100:103], a[28:31], a[220:223], v[100:103]
  ds_read_b128 a[172:175], v19 offset:55296
  v_cvt_pk_bf16_f32 v61, v110, v111
  v_mfma_f32_16x16x32_bf16 v[104:107], a[52:55], a[220:223], v[104:107]
  ds_read_b128 a[176:179], v18 offset:56320
  v_cvt_pk_bf16_f32 v76, v112, v113
  s_waitcnt lgkmcnt(13)
  v_mfma_f32_16x16x32_bf16 v[96:99], a[8:11], a[224:227], v[96:99]
  ds_read_b128 a[180:183], v19 offset:56320
  v_cvt_pk_bf16_f32 v77, v114, v115
  v_mfma_f32_16x16x32_bf16 v[100:103], a[32:35], a[224:227], v[100:103]
  ds_read_b128 a[184:187], v18 offset:57344
  v_cvt_pk_bf16_f32 v92, v116, v117
  v_mfma_f32_16x16x32_bf16 v[104:107], a[56:59], a[224:227], v[104:107]
  ds_read_b128 a[188:191], v19 offset:57344
  v_cvt_pk_bf16_f32 v93, v118, v119
  s_waitcnt lgkmcnt(13)
  v_mfma_f32_16x16x32_bf16 v[96:99], a[12:15], a[228:231], v[96:99]
  s_waitcnt lgkmcnt(7)
  buffer_store_dwordx4 a[244:247], v38, s[12:15], 0 offen offset:0 sc1
  v_mfma_f32_16x16x32_bf16 v[100:103], a[36:39], a[228:231], v[100:103]
  v_permlane32_swap_b32 v240, v241
  v_max_f32 v240, v240, v241
  v_mfma_f32_16x16x32_bf16 v[104:107], a[60:63], a[228:231], v[104:107]
  v_mov_b32 v241, v240
  v_mfma_f32_16x16x32_bf16 v[96:99], a[16:19], a[232:235], v[96:99]
  s_nop 0
  v_permlane16_swap_b32 v240, v241
  v_max_f32 v240, v240, v241
  v_mfma_f32_16x16x32_bf16 v[100:103], a[40:43], a[232:235], v[100:103]
  v_sub_f32 v168, v168, v240
  v_sub_f32 v169, v169, v240
  v_mfma_f32_16x16x32_bf16 v[104:107], a[64:67], a[232:235], v[104:107]
  v_sub_f32 v170, v170, v240
  v_sub_f32 v171, v171, v240
  v_mfma_f32_16x16x32_bf16 v[96:99], a[20:23], a[236:239], v[96:99]
  v_sub_f32 v172, v172, v240
  v_sub_f32 v173, v173, v240
  v_mfma_f32_16x16x32_bf16 v[100:103], a[44:47], a[236:239], v[100:103]
  v_sub_f32 v174, v174, v240
  v_sub_f32 v175, v175, v240
  v_mfma_f32_16x16x32_bf16 v[104:107], a[68:71], a[236:239], v[104:107]
  v_sub_f32 v176, v176, v240
  v_sub_f32 v177, v177, v240
  v_mfma_f32_16x16x32_bf16 v[108:111], a[0:3], a[144:147], 0
  v_sub_f32 v178, v178, v240
  v_sub_f32 v179, v179, v240
  v_mfma_f32_16x16x32_bf16 v[112:115], a[24:27], a[144:147], 0
  v_sub_f32 v180, v180, v240
  v_sub_f32 v181, v181, v240
  v_mfma_f32_16x16x32_bf16 v[116:119], a[48:51], a[144:147], 0
  v_exp_f32 v168, v168
  v_mfma_f32_16x16x32_bf16 v[108:111], a[4:7], a[148:151], v[108:111]
  v_exp_f32 v169, v169
  v_mfma_f32_16x16x32_bf16 v[112:115], a[28:31], a[148:151], v[112:115]
  ds_read_b128 a[248:251], v34 offset:0
  v_cvt_pk_bf16_f32 v96, v96, v97
  v_mfma_f32_16x16x32_bf16 v[116:119], a[52:55], a[148:151], v[116:119]
  v_exp_f32 v170, v170
  v_mfma_f32_16x16x32_bf16 v[108:111], a[8:11], a[152:155], v[108:111]
  v_exp_f32 v171, v171
  v_mfma_f32_16x16x32_bf16 v[112:115], a[32:35], a[152:155], v[112:115]
  v_exp_f32 v172, v172
  v_mfma_f32_16x16x32_bf16 v[116:119], a[56:59], a[152:155], v[116:119]
  v_exp_f32 v173, v173
  v_mfma_f32_16x16x32_bf16 v[108:111], a[12:15], a[156:159], v[108:111]
  v_exp_f32 v174, v174
  v_mfma_f32_16x16x32_bf16 v[112:115], a[36:39], a[156:159], v[112:115]
  v_exp_f32 v175, v175
  v_mfma_f32_16x16x32_bf16 v[116:119], a[60:63], a[156:159], v[116:119]
  s_waitcnt lgkmcnt(0)
  buffer_store_dwordx4 a[248:251], v39, s[12:15], 0 offen offset:0 sc1
  v_cvt_pk_bf16_f32 v97, v98, v99
  v_mfma_f32_16x16x32_bf16 v[108:111], a[16:19], a[160:163], v[108:111]
  v_exp_f32 v176, v176
  v_mfma_f32_16x16x32_bf16 v[112:115], a[40:43], a[160:163], v[112:115]
  v_exp_f32 v177, v177
  v_mfma_f32_16x16x32_bf16 v[116:119], a[64:67], a[160:163], v[116:119]
  v_exp_f32 v178, v178
  v_mfma_f32_16x16x32_bf16 v[108:111], a[20:23], a[164:167], v[108:111]
  v_exp_f32 v179, v179
  v_mfma_f32_16x16x32_bf16 v[112:115], a[44:47], a[164:167], v[112:115]
  v_exp_f32 v180, v180
  v_mfma_f32_16x16x32_bf16 v[116:119], a[68:71], a[164:167], v[116:119]
  v_exp_f32 v181, v181
  v_mfma_f32_16x16x32_bf16 v[120:123], a[0:3], a[168:171], 0
  v_add_f32 v240, v168, v169
  v_add_f32 v240, v240, v170
  v_mfma_f32_16x16x32_bf16 v[124:127], a[24:27], a[168:171], 0
  v_add_f32 v240, v240, v171
  v_add_f32 v240, v240, v172
  v_mfma_f32_16x16x32_bf16 v[128:131], a[48:51], a[168:171], 0
  v_add_f32 v240, v240, v173
  v_add_f32 v240, v240, v174
  v_mfma_f32_16x16x32_bf16 v[120:123], a[4:7], a[172:175], v[120:123]
  v_add_f32 v240, v240, v175
  v_add_f32 v240, v240, v176
  v_mfma_f32_16x16x32_bf16 v[124:127], a[28:31], a[172:175], v[124:127]
  v_add_f32 v240, v240, v177
  v_add_f32 v240, v240, v178
  v_mfma_f32_16x16x32_bf16 v[128:131], a[52:55], a[172:175], v[128:131]
  v_add_f32 v240, v240, v179
  v_add_f32 v240, v240, v180
  v_mfma_f32_16x16x32_bf16 v[120:123], a[8:11], a[176:179], v[120:123]
  ds_read_b128 a[252:255], v35 offset:0
  v_add_f32 v240, v240, v181
  v_mfma_f32_16x16x32_bf16 v[124:127], a[32:35], a[176:179], v[124:127]
  v_mov_b32 v241, v240
  v_cvt_pk_bf16_f32 v98, v100, v101
  v_mfma_f32_16x16x32_bf16 v[128:131], a[56:59], a[176:179], v[128:131]
  v_permlane32_swap_b32 v240, v241
  v_add_f32 v240, v240, v241
  v_mfma_f32_16x16x32_bf16 v[120:123], a[12:15], a[180:183], v[120:123]
  v_mov_b32 v241, v240
  v_cvt_pk_bf16_f32 v99, v102, v103
  v_mfma_f32_16x16x32_bf16 v[124:127], a[36:39], a[180:183], v[124:127]
  v_permlane16_swap_b32 v240, v241
  v_add_f32 v240, v240, v241
  v_mfma_f32_16x16x32_bf16 v[128:131], a[60:63], a[180:183], v[128:131]
  v_rcp_f32 v240, v240
  v_mfma_f32_16x16x32_bf16 v[120:123], a[16:19], a[184:187], v[120:123]
  v_mul_f32 v168, v168, v240
  v_mul_f32 v169, v169, v240
  v_mfma_f32_16x16x32_bf16 v[124:127], a[40:43], a[184:187], v[124:127]
  s_waitcnt lgkmcnt(0)
  buffer_store_dwordx4 a[252:255], v40, s[12:15], 0 offen offset:0 sc1
  v_mul_f32 v170, v170, v240
  v_mfma_f32_16x16x32_bf16 v[128:131], a[64:67], a[184:187], v[128:131]
  v_mul_f32 v171, v171, v240
  v_mul_f32 v172, v172, v240
  v_mfma_f32_16x16x32_bf16 v[120:123], a[20:23], a[188:191], v[120:123]
  v_mul_f32 v173, v173, v240
  v_mul_f32 v174, v174, v240
  v_mfma_f32_16x16x32_bf16 v[124:127], a[44:47], a[188:191], v[124:127]
  v_mul_f32 v175, v175, v240
  v_cvt_pk_bf16_f32 v168, v168, v169
  v_mfma_f32_16x16x32_bf16 v[128:131], a[68:71], a[188:191], v[128:131]
  v_cvt_pk_bf16_f32 v169, v170, v171
  v_cvt_pk_bf16_f32 v170, v172, v173
  v_mfma_f32_16x16x32_bf16 v[132:135], a[216:219], a[72:75], 0
  v_cvt_pk_bf16_f32 v171, v174, v175
  ds_write_b128 v28, v[168:171] offset:8192
  v_mfma_f32_16x16x32_bf16 v[136:139], a[216:219], a[96:99], 0
  v_mul_f32 v176, v176, v240
  v_mul_f32 v177, v177, v240
  v_mfma_f32_16x16x32_bf16 v[140:143], a[216:219], a[120:123], 0
  v_mul_f32 v178, v178, v240
  v_mul_f32 v179, v179, v240
  v_mfma_f32_16x16x32_bf16 v[132:135], a[220:223], a[76:79], v[132:135]
  v_mul_f32 v180, v180, v240
  v_mul_f32 v181, v181, v240
  v_mfma_f32_16x16x32_bf16 v[136:139], a[220:223], a[100:103], v[136:139]
  v_cvt_pk_bf16_f32 v176, v176, v177
  v_cvt_pk_bf16_f32 v177, v178, v179
  v_mfma_f32_16x16x32_bf16 v[140:143], a[220:223], a[124:127], v[140:143]
  v_cvt_pk_bf16_f32 v178, v180, v181
  v_cvt_pk_bf16_f32 v179, 0, 0
  v_mfma_f32_16x16x32_bf16 v[132:135], a[224:227], a[80:83], v[132:135]
  ds_write_b128 v28, v[176:179] offset:9216
  ds_write_b128 v24, v[96:99] offset:43008
  v_mfma_f32_16x16x32_bf16 v[136:139], a[224:227], a[104:107], v[136:139]
  v_cvt_pk_bf16_f32 v104, v104, v105
  v_cvt_pk_bf16_f32 v105, v106, v107
  v_mfma_f32_16x16x32_bf16 v[140:143], a[224:227], a[128:131], v[140:143]
  ds_write_b64 v25, v[104:105] offset:43008
  v_cvt_pk_bf16_f32 v108, v108, v109
  v_mfma_f32_16x16x32_bf16 v[132:135], a[228:231], a[84:87], v[132:135]
  v_cvt_pk_bf16_f32 v109, v110, v111
  v_cvt_pk_bf16_f32 v110, v112, v113
  v_mfma_f32_16x16x32_bf16 v[136:139], a[228:231], a[108:111], v[136:139]
  v_cvt_pk_bf16_f32 v111, v114, v115
  ds_write_b128 v24, v[108:111] offset:0
  v_mfma_f32_16x16x32_bf16 v[140:143], a[228:231], a[132:135], v[140:143]
  v_cvt_pk_bf16_f32 v116, v116, v117
  v_cvt_pk_bf16_f32 v117, v118, v119
  v_mfma_f32_16x16x32_bf16 v[132:135], a[232:235], a[88:91], v[132:135]
  ds_write_b64 v25, v[116:117] offset:0
  v_cvt_pk_bf16_f32 v120, v120, v121
  v_mfma_f32_16x16x32_bf16 v[136:139], a[232:235], a[112:115], v[136:139]
  v_cvt_pk_bf16_f32 v121, v122, v123
  v_cvt_pk_bf16_f32 v122, v124, v125
  v_mfma_f32_16x16x32_bf16 v[140:143], a[232:235], a[136:139], v[140:143]
  v_cvt_pk_bf16_f32 v123, v126, v127
  ds_write_b128 v24, v[120:123] offset:6144
  v_mfma_f32_16x16x32_bf16 v[132:135], a[236:239], a[92:95], v[132:135]
  v_cvt_pk_bf16_f32 v128, v128, v129
  v_cvt_pk_bf16_f32 v129, v130, v131
  v_mfma_f32_16x16x32_bf16 v[136:139], a[236:239], a[116:119], v[136:139]
  ds_write_b64 v25, v[128:129] offset:6144
  v_mfma_f32_16x16x32_bf16 v[140:143], a[236:239], a[140:143], v[140:143]
  s_nop 2
  v_cvt_pk_bf16_f32 v62, v132, v133
  v_cvt_pk_bf16_f32 v63, v134, v135
  s_nop 0
  v_cvt_pk_bf16_f32 v78, v136, v137
  v_cvt_pk_bf16_f32 v79, v138, v139
  v_cvt_pk_bf16_f32 v94, v140, v141
  v_cvt_pk_bf16_f32 v95, v142, v143
  s_waitcnt vmcnt(4)
  s_waitcnt lgkmcnt(0)
  s_barrier
  v_mfma_f32_16x16x32_bf16 v[144:147], a[144:147], a[72:75], 0
  ds_read_b128 v[208:211], v29 offset:8192
  ds_read_b128 v[212:215], v29 offset:9216
  v_mfma_f32_16x16x32_bf16 v[148:151], a[144:147], a[96:99], 0
  ds_read_b128 v[216:219], v29 offset:10240
  ds_read_b128 v[220:223], v29 offset:11264
  v_mfma_f32_16x16x32_bf16 v[152:155], a[144:147], a[120:123], 0
  ds_read_b128 v[224:227], v29 offset:12288
  ds_read_b128 v[228:231], v29 offset:13312
  v_mfma_f32_16x16x32_bf16 v[144:147], a[148:151], a[76:79], v[144:147]
  ds_read_b128 v[232:235], v29 offset:14336
  ds_read_b128 v[236:239], v29 offset:15360
  v_mfma_f32_16x16x32_bf16 v[148:151], a[148:151], a[100:103], v[148:151]
  ds_read_b128 v[184:187], v26 offset:0
  ds_read_b128 v[188:191], v26 offset:1024
  v_mfma_f32_16x16x32_bf16 v[152:155], a[148:151], a[124:127], v[152:155]
  ds_read_b128 v[192:195], v26 offset:2048
  ds_read_b128 v[196:199], v26 offset:3072
  v_mfma_f32_16x16x32_bf16 v[144:147], a[152:155], a[80:83], v[144:147]
  ds_read_b128 v[200:203], v26 offset:4096
  ds_read_b128 v[204:207], v26 offset:5120
  v_mfma_f32_16x16x32_bf16 v[148:151], a[152:155], a[104:107], v[148:151]
  v_mov_b32 v245, v30
  v_mfma_f32_16x16x32_bf16 v[152:155], a[152:155], a[128:131], v[152:155]
  s_waitcnt lgkmcnt(13)
  v_mfma_f32_16x16x32_bf16 v[156:159], v[54:57], v[208:211], 0
  v_mfma_f32_16x16x32_bf16 v[160:163], v[70:73], v[208:211], 0
  v_mfma_f32_16x16x32_bf16 v[164:167], v[86:89], v[208:211], 0
  s_waitcnt lgkmcnt(12)
  v_mfma_f32_16x16x32_bf16 v[156:159], v[58:61], v[212:215], v[156:159]
  ds_read_b128 a[240:243], v36 offset:0
  v_mfma_f32_16x16x32_bf16 v[160:163], v[74:77], v[212:215], v[160:163]
  v_mfma_f32_16x16x32_bf16 v[164:167], v[90:93], v[212:215], v[164:167]
  s_waitcnt lgkmcnt(12)
  v_mfma_f32_16x16x32_bf16 v[96:99], v[54:57], v[216:219], 0
  v_mfma_f32_16x16x32_bf16 v[100:103], v[70:73], v[216:219], 0
  v_mfma_f32_16x16x32_bf16 v[104:107], v[86:89], v[216:219], 0
  s_waitcnt lgkmcnt(11)
  v_mfma_f32_16x16x32_bf16 v[96:99], v[58:61], v[220:223], v[96:99]
  v_cvt_pk_bf16_f32 v156, v156, v157
  v_cvt_pk_bf16_f32 v157, v158, v159
  v_mfma_f32_16x16x32_bf16 v[100:103], v[74:77], v[220:223], v[100:103]
  s_waitcnt lgkmcnt(0)
  buffer_store_dwordx4 a[240:243], v14, s[12:15], 0 offen offset:0 sc1
  v_cvt_pk_bf16_f32 v158, v160, v161
  v_mfma_f32_16x16x32_bf16 v[104:107], v[90:93], v[220:223], v[104:107]
  v_cvt_pk_bf16_f32 v159, v162, v163
  ds_write_b128 v12, v[156:159] offset:25600
  v_mfma_f32_16x16x32_bf16 v[108:111], v[54:57], v[224:227], 0
  v_cvt_pk_bf16_f32 v164, v164, v165
  v_cvt_pk_bf16_f32 v165, v166, v167
  v_mfma_f32_16x16x32_bf16 v[112:115], v[70:73], v[224:227], 0
  ds_write_b64 v13, v[164:165] offset:25600
  v_mfma_f32_16x16x32_bf16 v[116:119], v[86:89], v[224:227], 0
  v_mfma_f32_16x16x32_bf16 v[108:111], v[58:61], v[228:231], v[108:111]
  v_cvt_pk_bf16_f32 v96, v96, v97
  v_cvt_pk_bf16_f32 v97, v98, v99
  v_mfma_f32_16x16x32_bf16 v[112:115], v[74:77], v[228:231], v[112:115]
  v_cvt_pk_bf16_f32 v98, v100, v101
  v_cvt_pk_bf16_f32 v99, v102, v103
  v_mfma_f32_16x16x32_bf16 v[116:119], v[90:93], v[228:231], v[116:119]
  ds_write_b128 v12, v[96:99] offset:32000
  v_cvt_pk_bf16_f32 v104, v104, v105
  v_mfma_f32_16x16x32_bf16 v[120:123], v[54:57], v[232:235], 0
  v_cvt_pk_bf16_f32 v105, v106, v107
  ds_write_b64 v13, v[104:105] offset:32000
  v_mfma_f32_16x16x32_bf16 v[124:127], v[70:73], v[232:235], 0
  v_mfma_f32_16x16x32_bf16 v[128:131], v[86:89], v[232:235], 0
  v_mfma_f32_16x16x32_bf16 v[120:123], v[58:61], v[236:239], v[120:123]
  v_cvt_pk_bf16_f32 v108, v108, v109
  v_cvt_pk_bf16_f32 v109, v110, v111
  v_mfma_f32_16x16x32_bf16 v[124:127], v[74:77], v[236:239], v[124:127]
  v_cvt_pk_bf16_f32 v110, v112, v113
  v_cvt_pk_bf16_f32 v111, v114, v115
  v_mfma_f32_16x16x32_bf16 v[128:131], v[90:93], v[236:239], v[128:131]
  ds_write_b128 v12, v[108:111] offset:38400
  v_cvt_pk_bf16_f32 v116, v116, v117
  v_mfma_f32_16x16x32_bf16 v[172:175], a[216:219], v[184:187], 0
  v_cvt_pk_bf16_f32 v117, v118, v119
  ds_write_b64 v13, v[116:117] offset:38400
  v_mfma_f32_16x16x32_bf16 v[176:179], a[144:147], v[184:187], 0
  v_mfma_f32_16x16x32_bf16 v[168:171], a[192:195], v[184:187], v[244:247]
  v_mfma_f32_16x16x32_bf16 v[180:183], a[168:171], v[184:187], v[248:251]
  v_cvt_pk_bf16_f32 v120, v120, v121
  v_cvt_pk_bf16_f32 v121, v122, v123
  v_mfma_f32_16x16x32_bf16 v[172:175], a[220:223], v[188:191], v[172:175]
  v_cvt_pk_bf16_f32 v122, v124, v125
  v_cvt_pk_bf16_f32 v123, v126, v127
  v_mfma_f32_16x16x32_bf16 v[176:179], a[148:151], v[188:191], v[176:179]
  ds_write_b128 v12, v[120:123] offset:44800
  v_cvt_pk_bf16_f32 v128, v128, v129
  v_mfma_f32_16x16x32_bf16 v[168:171], a[196:199], v[188:191], v[168:171]
  v_cvt_pk_bf16_f32 v129, v130, v131
  ds_write_b64 v13, v[128:129] offset:44800
  v_mfma_f32_16x16x32_bf16 v[180:183], a[172:175], v[188:191], v[180:183]
  s_add_u32 s27, s21, 9
  s_and_b32 s27, s27, 7
  v_mfma_f32_16x16x32_bf16 v[172:175], a[224:227], v[192:195], v[172:175]
  s_mul_i32 s27, s27, 6144
  v_add_u32 v26, s27, v27
  v_mfma_f32_16x16x32_bf16 v[176:179], a[152:155], v[192:195], v[176:179]
  v_mfma_f32_16x16x32_bf16 v[168:171], a[200:203], v[192:195], v[168:171]
  v_mfma_f32_16x16x32_bf16 v[180:183], a[176:179], v[192:195], v[180:183]
  v_mfma_f32_16x16x32_bf16 v[172:175], a[228:231], v[196:199], v[172:175]
  v_mfma_f32_16x16x32_bf16 v[176:179], a[156:159], v[196:199], v[176:179]
  v_mfma_f32_16x16x32_bf16 v[168:171], a[204:207], v[196:199], v[168:171]
  s_waitcnt lgkmcnt(0)
  s_barrier
  v_mfma_f32_16x16x32_bf16 v[180:183], a[180:183], v[196:199], v[180:183]
  ds_read_b128 a[240:243], v32 offset:26000
  v_mfma_f32_16x16x32_bf16 v[172:175], a[232:235], v[200:203], v[172:175]
  v_mfma_f32_16x16x32_bf16 v[176:179], a[160:163], v[200:203], v[176:179]
  v_mfma_f32_16x16x32_bf16 v[168:171], a[208:211], v[200:203], v[168:171]
  v_mfma_f32_16x16x32_bf16 v[180:183], a[184:187], v[200:203], v[180:183]
  v_mfma_f32_16x16x32_bf16 v[172:175], a[236:239], v[204:207], v[172:175]
  v_mfma_f32_16x16x32_bf16 v[176:179], a[164:167], v[204:207], v[176:179]
  v_mfma_f32_16x16x32_bf16 v[168:171], a[212:215], v[204:207], v[168:171]
  s_waitcnt lgkmcnt(0)
  buffer_store_dwordx4 a[240:243], v37, s[12:15], s62 offen offset:0 sc1
  v_mfma_f32_16x16x32_bf16 v[180:183], a[188:191], v[204:207], v[180:183]
  v_mfma_f32_16x16x32_bf16 v[144:147], a[156:159], a[84:87], v[144:147]
  ds_read_b128 a[192:195], v20 offset:0
  v_mfma_f32_16x16x32_bf16 v[148:151], a[156:159], a[108:111], v[148:151]
  ds_read_b128 a[196:199], v21 offset:0
  v_mfma_f32_16x16x32_bf16 v[152:155], a[156:159], a[132:135], v[152:155]
  ds_read_b128 a[200:203], v20 offset:1024
  v_mfma_f32_16x16x32_bf16 v[144:147], a[160:163], a[88:91], v[144:147]
  ds_read_b128 a[204:207], v21 offset:1024
  v_max3_f32 v240, v172, v173, v174
  v_mfma_f32_16x16x32_bf16 v[148:151], a[160:163], a[112:115], v[148:151]
  ds_read_b128 a[208:211], v20 offset:2048
  v_max3_f32 v240, v240, v175, v176
  v_mfma_f32_16x16x32_bf16 v[152:155], a[160:163], a[136:139], v[152:155]
  ds_read_b128 a[212:215], v21 offset:2048
  v_max3_f32 v240, v240, v177, v178
  v_mfma_f32_16x16x32_bf16 v[144:147], a[164:167], a[92:95], v[144:147]
  ds_read_b128 a[216:219], v20 offset:6144
  v_max3_f32 v240, v240, v179, v168
  v_mfma_f32_16x16x32_bf16 v[148:151], a[164:167], a[116:119], v[148:151]
  ds_read_b128 a[220:223], v21 offset:6144
  v_max3_f32 v240, v240, v169, v170
  v_mfma_f32_16x16x32_bf16 v[152:155], a[164:167], a[140:143], v[152:155]
  ds_read_b128 a[224:227], v20 offset:7168
  v_max3_f32 v240, v240, v171, v180
  v_mfma_f32_16x16x32_bf16 v[132:135], a[168:171], a[72:75], 0
  ds_read_b128 a[228:231], v21 offset:7168
  v_max3_f32 v240, v240, v181, v182
  v_mfma_f32_16x16x32_bf16 v[136:139], a[168:171], a[96:99], 0
  ds_read_b128 a[232:235], v20 offset:8192
  v_mov_b32 v241, v240
  v_mfma_f32_16x16x32_bf16 v[140:143], a[168:171], a[120:123], 0
  ds_read_b128 a[244:247], v33 offset:26000
  ds_read_b128 a[236:239], v21 offset:8192
  v_mfma_f32_16x16x32_bf16 v[132:135], a[172:175], a[76:79], v[132:135]
  ds_read_b128 a[144:147], v22 offset:0
  v_cvt_pk_bf16_f32 v48, v144, v145
  v_mfma_f32_16x16x32_bf16 v[136:139], a[172:175], a[100:103], v[136:139]
  ds_read_b128 a[148:151], v23 offset:0
  v_cvt_pk_bf16_f32 v49, v146, v147
  v_mfma_f32_16x16x32_bf16 v[140:143], a[172:175], a[124:127], v[140:143]
  ds_read_b128 a[152:155], v22 offset:1024
  v_cvt_pk_bf16_f32 v64, v148, v149
  v_mfma_f32_16x16x32_bf16 v[132:135], a[176:179], a[80:83], v[132:135]
  ds_read_b128 a[156:159], v23 offset:1024
  v_cvt_pk_bf16_f32 v65, v150, v151
  v_mfma_f32_16x16x32_bf16 v[136:139], a[176:179], a[104:107], v[136:139]
  ds_read_b128 a[160:163], v22 offset:2048
  v_cvt_pk_bf16_f32 v80, v152, v153
  v_mfma_f32_16x16x32_bf16 v[140:143], a[176:179], a[128:131], v[140:143]
  ds_read_b128 a[164:167], v23 offset:2048
  v_cvt_pk_bf16_f32 v81, v154, v155
  v_mfma_f32_16x16x32_bf16 v[132:135], a[180:183], a[84:87], v[132:135]
  s_waitcnt lgkmcnt(7)
  buffer_store_dwordx4 a[244:247], v38, s[12:15], s62 offen offset:0 sc1
  v_mfma_f32_16x16x32_bf16 v[136:139], a[180:183], a[108:111], v[136:139]
  v_permlane32_swap_b32 v240, v241
  v_max_f32 v240, v240, v241
  v_mfma_f32_16x16x32_bf16 v[140:143], a[180:183], a[132:135], v[140:143]
  v_mov_b32 v241, v240
  v_mfma_f32_16x16x32_bf16 v[132:135], a[184:187], a[88:91], v[132:135]
  s_nop 0
  v_permlane16_swap_b32 v240, v241
  v_max_f32 v240, v240, v241
  v_mfma_f32_16x16x32_bf16 v[136:139], a[184:187], a[112:115], v[136:139]
  v_sub_f32 v168, v168, v240
  v_sub_f32 v169, v169, v240
  v_mfma_f32_16x16x32_bf16 v[140:143], a[184:187], a[136:139], v[140:143]
  v_sub_f32 v170, v170, v240
  v_sub_f32 v171, v171, v240
  v_mfma_f32_16x16x32_bf16 v[132:135], a[188:191], a[92:95], v[132:135]
  v_sub_f32 v172, v172, v240
  v_sub_f32 v173, v173, v240
  v_mfma_f32_16x16x32_bf16 v[136:139], a[188:191], a[116:119], v[136:139]
  v_sub_f32 v174, v174, v240
  v_sub_f32 v175, v175, v240
  v_mfma_f32_16x16x32_bf16 v[140:143], a[188:191], a[140:143], v[140:143]
  v_sub_f32 v176, v176, v240
  v_sub_f32 v177, v177, v240
  v_mfma_f32_16x16x32_bf16 v[144:147], a[0:3], a[192:195], 0
  v_sub_f32 v178, v178, v240
  v_sub_f32 v179, v179, v240
  v_mfma_f32_16x16x32_bf16 v[148:151], a[24:27], a[192:195], 0
  v_sub_f32 v180, v180, v240
  v_sub_f32 v181, v181, v240
  v_mfma_f32_16x16x32_bf16 v[152:155], a[48:51], a[192:195], 0
  v_sub_f32 v182, v182, v240
  v_mfma_f32_16x16x32_bf16 v[144:147], a[4:7], a[196:199], v[144:147]
  v_exp_f32 v168, v168
  v_mfma_f32_16x16x32_bf16 v[148:151], a[28:31], a[196:199], v[148:151]
  ds_read_b128 a[248:251], v34 offset:26000
  v_cvt_pk_bf16_f32 v50, v132, v133
  v_mfma_f32_16x16x32_bf16 v[152:155], a[52:55], a[196:199], v[152:155]
  v_exp_f32 v169, v169
  v_mfma_f32_16x16x32_bf16 v[144:147], a[8:11], a[200:203], v[144:147]
  v_exp_f32 v170, v170
  v_mfma_f32_16x16x32_bf16 v[148:151], a[32:35], a[200:203], v[148:151]
  v_exp_f32 v171, v171
  v_mfma_f32_16x16x32_bf16 v[152:155], a[56:59], a[200:203], v[152:155]
  v_exp_f32 v172, v172
  v_mfma_f32_16x16x32_bf16 v[144:147], a[12:15], a[204:207], v[144:147]
  v_exp_f32 v173, v173
  v_mfma_f32_16x16x32_bf16 v[148:151], a[36:39], a[204:207], v[148:151]
  v_exp_f32 v174, v174
  v_mfma_f32_16x16x32_bf16 v[152:155], a[60:63], a[204:207], v[152:155]
  s_waitcnt lgkmcnt(0)
  buffer_store_dwordx4 a[248:251], v39, s[12:15], s62 offen offset:0 sc1
  v_cvt_pk_bf16_f32 v51, v134, v135
  v_mfma_f32_16x16x32_bf16 v[144:147], a[16:19], a[208:211], v[144:147]
  v_exp_f32 v175, v175
  v_mfma_f32_16x16x32_bf16 v[148:151], a[40:43], a[208:211], v[148:151]
  v_exp_f32 v176, v176
  v_mfma_f32_16x16x32_bf16 v[152:155], a[64:67], a[208:211], v[152:155]
  v_exp_f32 v177, v177
  v_mfma_f32_16x16x32_bf16 v[144:147], a[20:23], a[212:215], v[144:147]
  v_exp_f32 v178, v178
  v_mfma_f32_16x16x32_bf16 v[148:151], a[44:47], a[212:215], v[148:151]
  v_exp_f32 v179, v179
  v_mfma_f32_16x16x32_bf16 v[152:155], a[68:71], a[212:215], v[152:155]
  v_exp_f32 v180, v180
  v_mfma_f32_16x16x32_bf16 v[156:159], a[0:3], a[216:219], 0
  v_exp_f32 v181, v181
  v_mfma_f32_16x16x32_bf16 v[160:163], a[24:27], a[216:219], 0
  v_exp_f32 v182, v182
  v_mfma_f32_16x16x32_bf16 v[164:167], a[48:51], a[216:219], 0
  v_add_f32 v240, v168, v169
  v_add_f32 v240, v240, v170
  v_mfma_f32_16x16x32_bf16 v[156:159], a[4:7], a[220:223], v[156:159]
  v_add_f32 v240, v240, v171
  v_add_f32 v240, v240, v172
  v_mfma_f32_16x16x32_bf16 v[160:163], a[28:31], a[220:223], v[160:163]
  v_add_f32 v240, v240, v173
  v_add_f32 v240, v240, v174
  v_mfma_f32_16x16x32_bf16 v[164:167], a[52:55], a[220:223], v[164:167]
  v_add_f32 v240, v240, v175
  v_add_f32 v240, v240, v176
  v_mfma_f32_16x16x32_bf16 v[156:159], a[8:11], a[224:227], v[156:159]
  ds_read_b128 a[252:255], v35 offset:26000
  v_add_f32 v240, v240, v177
  v_mfma_f32_16x16x32_bf16 v[160:163], a[32:35], a[224:227], v[160:163]
  v_add_f32 v240, v240, v178
  v_add_f32 v240, v240, v179
  v_mfma_f32_16x16x32_bf16 v[164:167], a[56:59], a[224:227], v[164:167]
  v_add_f32 v240, v240, v180
  v_add_f32 v240, v240, v181
  v_mfma_f32_16x16x32_bf16 v[156:159], a[12:15], a[228:231], v[156:159]
  v_add_f32 v240, v240, v182
  v_mov_b32 v241, v240
  v_mfma_f32_16x16x32_bf16 v[160:163], a[36:39], a[228:231], v[160:163]
  s_nop 0
  v_permlane32_swap_b32 v240, v241
  v_add_f32 v240, v240, v241
  v_mfma_f32_16x16x32_bf16 v[164:167], a[60:63], a[228:231], v[164:167]
  v_mov_b32 v241, v240
  v_cvt_pk_bf16_f32 v66, v136, v137
  v_mfma_f32_16x16x32_bf16 v[156:159], a[16:19], a[232:235], v[156:159]
  v_permlane16_swap_b32 v240, v241
  v_add_f32 v240, v240, v241
  v_mfma_f32_16x16x32_bf16 v[160:163], a[40:43], a[232:235], v[160:163]
  s_waitcnt lgkmcnt(0)
  buffer_store_dwordx4 a[252:255], v40, s[12:15], s62 offen offset:0 sc1
  v_cvt_pk_bf16_f32 v67, v138, v139
  v_mfma_f32_16x16x32_bf16 v[164:167], a[64:67], a[232:235], v[164:167]
  v_rcp_f32 v240, v240
  v_mfma_f32_16x16x32_bf16 v[156:159], a[20:23], a[236:239], v[156:159]
  v_mul_f32 v168, v168, v240
  v_mul_f32 v169, v169, v240
  v_mfma_f32_16x16x32_bf16 v[160:163], a[44:47], a[236:239], v[160:163]
  v_mul_f32 v170, v170, v240
  v_mul_f32 v171, v171, v240
  v_mfma_f32_16x16x32_bf16 v[164:167], a[68:71], a[236:239], v[164:167]
  v_mul_f32 v172, v172, v240
  v_mul_f32 v173, v173, v240
  v_mfma_f32_16x16x32_bf16 v[96:99], a[0:3], a[144:147], 0
  v_mul_f32 v174, v174, v240
  v_mul_f32 v175, v175, v240
  v_mfma_f32_16x16x32_bf16 v[100:103], a[24:27], a[144:147], 0
  v_cvt_pk_bf16_f32 v168, v168, v169
  v_cvt_pk_bf16_f32 v169, v170, v171
  v_mfma_f32_16x16x32_bf16 v[104:107], a[48:51], a[144:147], 0
  v_cvt_pk_bf16_f32 v170, v172, v173
  v_cvt_pk_bf16_f32 v171, v174, v175
  v_mfma_f32_16x16x32_bf16 v[96:99], a[4:7], a[148:151], v[96:99]
  ds_write_b128 v28, v[168:171] offset:0
  v_mul_f32 v176, v176, v240
  v_mfma_f32_16x16x32_bf16 v[100:103], a[28:31], a[148:151], v[100:103]
  v_mul_f32 v177, v177, v240
  v_mul_f32 v178, v178, v240
  v_mfma_f32_16x16x32_bf16 v[104:107], a[52:55], a[148:151], v[104:107]
  v_mul_f32 v179, v179, v240
  v_mul_f32 v180, v180, v240
  v_mfma_f32_16x16x32_bf16 v[96:99], a[8:11], a[152:155], v[96:99]
  v_mul_f32 v181, v181, v240
  v_mul_f32 v182, v182, v240
  v_mfma_f32_16x16x32_bf16 v[100:103], a[32:35], a[152:155], v[100:103]
  v_cvt_pk_bf16_f32 v176, v176, v177
  v_cvt_pk_bf16_f32 v177, v178, v179
  v_mfma_f32_16x16x32_bf16 v[104:107], a[56:59], a[152:155], v[104:107]
  v_cvt_pk_bf16_f32 v178, v180, v181
  v_cvt_pk_bf16_f32 v179, v182, 0
  v_mfma_f32_16x16x32_bf16 v[96:99], a[12:15], a[156:159], v[96:99]
  ds_write_b128 v28, v[176:179] offset:1024
  v_cvt_pk_bf16_f32 v82, v140, v141
  v_mfma_f32_16x16x32_bf16 v[100:103], a[36:39], a[156:159], v[100:103]
  v_cvt_pk_bf16_f32 v83, v142, v143
  v_cvt_pk_bf16_f32 v144, v144, v145
  v_mfma_f32_16x16x32_bf16 v[104:107], a[60:63], a[156:159], v[104:107]
  v_cvt_pk_bf16_f32 v145, v146, v147
  v_cvt_pk_bf16_f32 v146, v148, v149
  v_mfma_f32_16x16x32_bf16 v[96:99], a[16:19], a[160:163], v[96:99]
  v_cvt_pk_bf16_f32 v147, v150, v151
  ds_write_b128 v24, v[144:147] offset:12288
  v_mfma_f32_16x16x32_bf16 v[100:103], a[40:43], a[160:163], v[100:103]
  v_cvt_pk_bf16_f32 v152, v152, v153
  v_cvt_pk_bf16_f32 v153, v154, v155
  v_mfma_f32_16x16x32_bf16 v[104:107], a[64:67], a[160:163], v[104:107]
  ds_write_b64 v25, v[152:153] offset:12288
  v_cvt_pk_bf16_f32 v156, v156, v157
  v_mfma_f32_16x16x32_bf16 v[96:99], a[20:23], a[164:167], v[96:99]
  v_cvt_pk_bf16_f32 v157, v158, v159
  v_cvt_pk_bf16_f32 v158, v160, v161
  v_mfma_f32_16x16x32_bf16 v[100:103], a[44:47], a[164:167], v[100:103]
  v_cvt_pk_bf16_f32 v159, v162, v163
  ds_write_b128 v24, v[156:159] offset:18432
  v_mfma_f32_16x16x32_bf16 v[104:107], a[68:71], a[164:167], v[104:107]
  v_cvt_pk_bf16_f32 v164, v164, v165
  v_cvt_pk_bf16_f32 v165, v166, v167
  ds_write_b64 v25, v[164:165] offset:18432
  v_cvt_pk_bf16_f32 v96, v96, v97
  v_cvt_pk_bf16_f32 v97, v98, v99
  v_cvt_pk_bf16_f32 v98, v100, v101
  v_cvt_pk_bf16_f32 v99, v102, v103
  ds_write_b128 v24, v[96:99] offset:24576
  v_cvt_pk_bf16_f32 v104, v104, v105
  v_cvt_pk_bf16_f32 v105, v106, v107
  ds_write_b64 v25, v[104:105] offset:24576
  s_waitcnt lgkmcnt(0)
  s_barrier
  v_mfma_f32_16x16x32_bf16 v[108:111], a[192:195], a[72:75], 0
  ds_read_b128 v[184:187], v26 offset:0
  ds_read_b128 v[188:191], v26 offset:1024
  v_mfma_f32_16x16x32_bf16 v[112:115], a[192:195], a[96:99], 0
  ds_read_b128 v[192:195], v26 offset:2048
  ds_read_b128 v[196:199], v26 offset:3072
  v_mfma_f32_16x16x32_bf16 v[116:119], a[192:195], a[120:123], 0
  ds_read_b128 v[200:203], v26 offset:4096
  ds_read_b128 v[204:207], v26 offset:5120
  v_mfma_f32_16x16x32_bf16 v[108:111], a[196:199], a[76:79], v[108:111]
  ds_read_b128 v[208:211], v29 offset:0
  ds_read_b128 v[212:215], v29 offset:1024
  v_mfma_f32_16x16x32_bf16 v[112:115], a[196:199], a[100:103], v[112:115]
  ds_read_b128 v[216:219], v29 offset:2048
  ds_read_b128 v[220:223], v29 offset:3072
  v_mfma_f32_16x16x32_bf16 v[116:119], a[196:199], a[124:127], v[116:119]
  ds_read_b128 v[224:227], v29 offset:4096
  ds_read_b128 v[228:231], v29 offset:5120
  v_mfma_f32_16x16x32_bf16 v[108:111], a[200:203], a[80:83], v[108:111]
  ds_read_b128 v[232:235], v29 offset:6144
  ds_read_b128 v[236:239], v29 offset:7168
  v_mov_b32 v246, v30
  v_mfma_f32_16x16x32_bf16 v[112:115], a[200:203], a[104:107], v[112:115]
  v_mfma_f32_16x16x32_bf16 v[116:119], a[200:203], a[128:131], v[116:119]
  s_waitcnt lgkmcnt(13)
  v_mfma_f32_16x16x32_bf16 v[172:175], a[192:195], v[184:187], 0
  v_mfma_f32_16x16x32_bf16 v[176:179], a[216:219], v[184:187], 0
  v_mfma_f32_16x16x32_bf16 v[168:171], a[168:171], v[184:187], v[244:247]
  v_mfma_f32_16x16x32_bf16 v[180:183], a[144:147], v[184:187], v[248:251]
  ds_read_b128 a[240:243], v36 offset:26000
  s_waitcnt lgkmcnt(13)
  v_mfma_f32_16x16x32_bf16 v[172:175], a[196:199], v[188:191], v[172:175]
  v_mfma_f32_16x16x32_bf16 v[176:179], a[220:223], v[188:191], v[176:179]
  v_mfma_f32_16x16x32_bf16 v[168:171], a[172:175], v[188:191], v[168:171]
  v_mfma_f32_16x16x32_bf16 v[180:183], a[148:151], v[188:191], v[180:183]
  s_waitcnt lgkmcnt(12)
  v_mfma_f32_16x16x32_bf16 v[172:175], a[200:203], v[192:195], v[172:175]
  v_mfma_f32_16x16x32_bf16 v[176:179], a[224:227], v[192:195], v[176:179]
  v_mfma_f32_16x16x32_bf16 v[168:171], a[176:179], v[192:195], v[168:171]
  s_waitcnt lgkmcnt(0)
  buffer_store_dwordx4 a[240:243], v14, s[12:15], s62 offen offset:0 sc1
  v_mfma_f32_16x16x32_bf16 v[180:183], a[152:155], v[192:195], v[180:183]
  v_mfma_f32_16x16x32_bf16 v[172:175], a[204:207], v[196:199], v[172:175]
  v_mfma_f32_16x16x32_bf16 v[176:179], a[228:231], v[196:199], v[176:179]
  v_mfma_f32_16x16x32_bf16 v[168:171], a[180:183], v[196:199], v[168:171]
  v_mfma_f32_16x16x32_bf16 v[180:183], a[156:159], v[196:199], v[180:183]
  v_mfma_f32_16x16x32_bf16 v[172:175], a[208:211], v[200:203], v[172:175]
  v_mfma_f32_16x16x32_bf16 v[176:179], a[232:235], v[200:203], v[176:179]
  v_mfma_f32_16x16x32_bf16 v[168:171], a[184:187], v[200:203], v[168:171]
  v_mfma_f32_16x16x32_bf16 v[180:183], a[160:163], v[200:203], v[180:183]
  v_mfma_f32_16x16x32_bf16 v[172:175], a[212:215], v[204:207], v[172:175]
  v_mfma_f32_16x16x32_bf16 v[176:179], a[236:239], v[204:207], v[176:179]
  v_mfma_f32_16x16x32_bf16 v[168:171], a[188:191], v[204:207], v[168:171]
  v_mfma_f32_16x16x32_bf16 v[180:183], a[164:167], v[204:207], v[180:183]
  v_mfma_f32_16x16x32_bf16 v[120:123], v[60:63], v[208:211], 0
  v_mfma_f32_16x16x32_bf16 v[124:127], v[76:79], v[208:211], 0
  v_mfma_f32_16x16x32_bf16 v[128:131], v[92:95], v[208:211], 0
  v_mfma_f32_16x16x32_bf16 v[120:123], v[48:51], v[212:215], v[120:123]
  s_nop 0
  v_max3_f32 v240, v172, v173, v174
  v_max3_f32 v240, v240, v175, v176
  v_mfma_f32_16x16x32_bf16 v[124:127], v[64:67], v[212:215], v[124:127]
  v_max3_f32 v240, v240, v177, v178
  v_max3_f32 v240, v240, v179, v168
  v_mfma_f32_16x16x32_bf16 v[128:131], v[80:83], v[212:215], v[128:131]
  v_max3_f32 v240, v240, v169, v170
  v_max3_f32 v240, v240, v171, v180
  v_mfma_f32_16x16x32_bf16 v[132:135], v[60:63], v[216:219], 0
  v_max3_f32 v240, v240, v181, v182
  v_max_f32 v240, v240, v183
  v_mfma_f32_16x16x32_bf16 v[136:139], v[76:79], v[216:219], 0
  v_mov_b32 v241, v240
  v_mfma_f32_16x16x32_bf16 v[140:143], v[92:95], v[216:219], 0
  s_nop 0
  v_permlane32_swap_b32 v240, v241
  v_max_f32 v240, v240, v241
  v_mfma_f32_16x16x32_bf16 v[132:135], v[48:51], v[220:223], v[132:135]
  v_mov_b32 v241, v240
  v_cvt_pk_bf16_f32 v120, v120, v121
  v_mfma_f32_16x16x32_bf16 v[136:139], v[64:67], v[220:223], v[136:139]
  v_permlane16_swap_b32 v240, v241
  v_max_f32 v240, v240, v241
  v_mfma_f32_16x16x32_bf16 v[140:143], v[80:83], v[220:223], v[140:143]
  v_sub_f32 v168, v168, v240
  v_sub_f32 v169, v169, v240
  v_mfma_f32_16x16x32_bf16 v[144:147], v[60:63], v[224:227], 0
  v_sub_f32 v170, v170, v240
  v_sub_f32 v171, v171, v240
  v_mfma_f32_16x16x32_bf16 v[148:151], v[76:79], v[224:227], 0
  v_sub_f32 v172, v172, v240
  v_sub_f32 v173, v173, v240
  v_mfma_f32_16x16x32_bf16 v[152:155], v[92:95], v[224:227], 0
  v_sub_f32 v174, v174, v240
  v_sub_f32 v175, v175, v240
  v_mfma_f32_16x16x32_bf16 v[144:147], v[48:51], v[228:231], v[144:147]
  v_sub_f32 v176, v176, v240
  v_sub_f32 v177, v177, v240
  v_mfma_f32_16x16x32_bf16 v[148:151], v[64:67], v[228:231], v[148:151]
  v_sub_f32 v178, v178, v240
  v_sub_f32 v179, v179, v240
  v_mfma_f32_16x16x32_bf16 v[152:155], v[80:83], v[228:231], v[152:155]
  v_sub_f32 v180, v180, v240
  v_sub_f32 v181, v181, v240
  v_mfma_f32_16x16x32_bf16 v[156:159], v[60:63], v[232:235], 0
  v_sub_f32 v182, v182, v240
  v_sub_f32 v183, v183, v240
  v_mfma_f32_16x16x32_bf16 v[160:163], v[76:79], v[232:235], 0
  v_exp_f32 v168, v168
  v_mfma_f32_16x16x32_bf16 v[164:167], v[92:95], v[232:235], 0
  v_exp_f32 v169, v169
  v_mfma_f32_16x16x32_bf16 v[156:159], v[48:51], v[236:239], v[156:159]
  v_exp_f32 v170, v170
  v_mfma_f32_16x16x32_bf16 v[160:163], v[64:67], v[236:239], v[160:163]
  v_exp_f32 v171, v171
  v_mfma_f32_16x16x32_bf16 v[164:167], v[80:83], v[236:239], v[164:167]
  v_exp_f32 v172, v172
  v_mfma_f32_16x16x32_bf16 v[108:111], a[204:207], a[84:87], v[108:111]
  v_exp_f32 v173, v173
  v_mfma_f32_16x16x32_bf16 v[112:115], a[204:207], a[108:111], v[112:115]
  v_exp_f32 v174, v174
  v_mfma_f32_16x16x32_bf16 v[116:119], a[204:207], a[132:135], v[116:119]
  v_exp_f32 v175, v175
  v_mfma_f32_16x16x32_bf16 v[108:111], a[208:211], a[88:91], v[108:111]
  v_exp_f32 v176, v176
  v_mfma_f32_16x16x32_bf16 v[112:115], a[208:211], a[112:115], v[112:115]
  v_exp_f32 v177, v177
  v_mfma_f32_16x16x32_bf16 v[116:119], a[208:211], a[136:139], v[116:119]
  v_exp_f32 v178, v178
  v_mfma_f32_16x16x32_bf16 v[108:111], a[212:215], a[92:95], v[108:111]
  v_exp_f32 v179, v179
  v_mfma_f32_16x16x32_bf16 v[112:115], a[212:215], a[116:119], v[112:115]
  v_exp_f32 v180, v180
  v_mfma_f32_16x16x32_bf16 v[116:119], a[212:215], a[140:143], v[116:119]
  v_exp_f32 v181, v181
  v_mfma_f32_16x16x32_bf16 v[96:99], a[216:219], a[72:75], 0
  v_exp_f32 v182, v182
  v_mfma_f32_16x16x32_bf16 v[100:103], a[216:219], a[96:99], 0
  v_exp_f32 v183, v183
  v_mfma_f32_16x16x32_bf16 v[104:107], a[216:219], a[120:123], 0
  v_add_f32 v240, v168, v169
  v_add_f32 v240, v240, v170
  v_mfma_f32_16x16x32_bf16 v[96:99], a[220:223], a[76:79], v[96:99]
  v_add_f32 v240, v240, v171
  v_add_f32 v240, v240, v172
  v_mfma_f32_16x16x32_bf16 v[100:103], a[220:223], a[100:103], v[100:103]
  v_add_f32 v240, v240, v173
  v_add_f32 v240, v240, v174
  v_cvt_pk_bf16_f32 v121, v122, v123
  v_cvt_pk_bf16_f32 v122, v124, v125
  v_cvt_pk_bf16_f32 v123, v126, v127
  ds_write_b128 v12, v[120:123] offset:0
  v_cvt_pk_bf16_f32 v128, v128, v129
  v_cvt_pk_bf16_f32 v129, v130, v131
  ds_write_b64 v13, v[128:129] offset:0
  v_cvt_pk_bf16_f32 v132, v132, v133
  v_cvt_pk_bf16_f32 v133, v134, v135
  v_cvt_pk_bf16_f32 v134, v136, v137
  v_cvt_pk_bf16_f32 v135, v138, v139
  ds_write_b128 v12, v[132:135] offset:6400
  v_cvt_pk_bf16_f32 v140, v140, v141
  v_cvt_pk_bf16_f32 v141, v142, v143
  ds_write_b64 v13, v[140:141] offset:6400
  v_cvt_pk_bf16_f32 v144, v144, v145
  v_cvt_pk_bf16_f32 v145, v146, v147
  v_cvt_pk_bf16_f32 v146, v148, v149
  v_cvt_pk_bf16_f32 v147, v150, v151
  ds_write_b128 v12, v[144:147] offset:12800
  v_cvt_pk_bf16_f32 v152, v152, v153
  v_cvt_pk_bf16_f32 v153, v154, v155
  ds_write_b64 v13, v[152:153] offset:12800
  v_cvt_pk_bf16_f32 v156, v156, v157
  v_cvt_pk_bf16_f32 v157, v158, v159
  v_cvt_pk_bf16_f32 v158, v160, v161
  v_cvt_pk_bf16_f32 v159, v162, v163
  ds_write_b128 v12, v[156:159] offset:19200
  v_cvt_pk_bf16_f32 v164, v164, v165
  v_cvt_pk_bf16_f32 v165, v166, v167
  ds_write_b64 v13, v[164:165] offset:19200
  v_mfma_f32_16x16x32_bf16 v[104:107], a[220:223], a[124:127], v[104:107]
  s_waitcnt lgkmcnt(0)
  s_barrier
  v_mfma_f32_16x16x32_bf16 v[96:99], a[224:227], a[80:83], v[96:99]
  ds_read_b128 v[208:211], v32 offset:800
  ds_read_b128 v[212:215], v33 offset:800
  v_mfma_f32_16x16x32_bf16 v[100:103], a[224:227], a[104:107], v[100:103]
  ds_read_b128 v[216:219], v34 offset:800
  ds_read_b128 v[220:223], v35 offset:800
  v_mfma_f32_16x16x32_bf16 v[104:107], a[224:227], a[128:131], v[104:107]
  ds_read_b128 v[224:227], v36 offset:800
  v_add_f32 v240, v240, v175
  v_mfma_f32_16x16x32_bf16 v[96:99], a[228:231], a[84:87], v[96:99]
  v_add_f32 v240, v240, v176
  v_add_f32 v240, v240, v177
  v_mfma_f32_16x16x32_bf16 v[100:103], a[228:231], a[108:111], v[100:103]
  v_add_f32 v240, v240, v178
  v_add_f32 v240, v240, v179
  v_mfma_f32_16x16x32_bf16 v[104:107], a[228:231], a[132:135], v[104:107]
  v_add_f32 v240, v240, v180
  v_add_f32 v240, v240, v181
  v_mfma_f32_16x16x32_bf16 v[96:99], a[232:235], a[88:91], v[96:99]
  v_add_f32 v240, v240, v182
  v_add_f32 v240, v240, v183
  v_mfma_f32_16x16x32_bf16 v[100:103], a[232:235], a[112:115], v[100:103]
  s_waitcnt lgkmcnt(4)
  buffer_store_dwordx4 v[208:211], v37, s[12:15], s63 offen offset:0 sc1
  v_mov_b32 v241, v240
  v_mfma_f32_16x16x32_bf16 v[104:107], a[232:235], a[136:139], v[104:107]
  s_nop 0
  v_permlane32_swap_b32 v240, v241
  v_add_f32 v240, v240, v241
  v_mfma_f32_16x16x32_bf16 v[96:99], a[236:239], a[92:95], v[96:99]
  v_mov_b32 v241, v240
  v_cvt_pk_bf16_f32 v52, v108, v109
  v_mfma_f32_16x16x32_bf16 v[100:103], a[236:239], a[116:119], v[100:103]
  v_permlane16_swap_b32 v240, v241
  v_add_f32 v240, v240, v241
  v_cvt_pk_bf16_f32 v53, v110, v111
  v_cvt_pk_bf16_f32 v68, v112, v113
  v_cvt_pk_bf16_f32 v69, v114, v115
  v_cvt_pk_bf16_f32 v84, v116, v117
  v_cvt_pk_bf16_f32 v85, v118, v119
  v_mfma_f32_16x16x32_bf16 v[104:107], a[236:239], a[140:143], v[104:107]
  v_rcp_f32 v240, v240
  v_mfma_f32_16x16x32_bf16 v[108:111], a[144:147], a[72:75], 0
  v_mul_f32 v168, v168, v240
  v_mul_f32 v169, v169, v240
  v_mfma_f32_16x16x32_bf16 v[112:115], a[144:147], a[96:99], 0
  v_mul_f32 v170, v170, v240
  v_mul_f32 v171, v171, v240
  v_mfma_f32_16x16x32_bf16 v[116:119], a[144:147], a[120:123], 0
  s_waitcnt lgkmcnt(0)
  buffer_store_dwordx4 v[212:215], v38, s[12:15], s63 offen offset:0 sc1
  v_mul_f32 v172, v172, v240
  v_mfma_f32_16x16x32_bf16 v[108:111], a[148:151], a[76:79], v[108:111]
  v_mul_f32 v173, v173, v240
  v_mul_f32 v174, v174, v240
  v_mfma_f32_16x16x32_bf16 v[112:115], a[148:151], a[100:103], v[112:115]
  v_mul_f32 v175, v175, v240
  v_cvt_pk_bf16_f32 v168, v168, v169
  v_mfma_f32_16x16x32_bf16 v[116:119], a[148:151], a[124:127], v[116:119]
  v_cvt_pk_bf16_f32 v169, v170, v171
  v_cvt_pk_bf16_f32 v170, v172, v173
  v_mfma_f32_16x16x32_bf16 v[108:111], a[152:155], a[80:83], v[108:111]
  v_cvt_pk_bf16_f32 v171, v174, v175
  ds_write_b128 v28, v[168:171] offset:8192
  v_mfma_f32_16x16x32_bf16 v[112:115], a[152:155], a[104:107], v[112:115]
  v_mul_f32 v176, v176, v240
  v_mul_f32 v177, v177, v240
  v_mfma_f32_16x16x32_bf16 v[116:119], a[152:155], a[128:131], v[116:119]
  v_mul_f32 v178, v178, v240
  v_mul_f32 v179, v179, v240
  v_mfma_f32_16x16x32_bf16 v[108:111], a[156:159], a[84:87], v[108:111]
  buffer_store_dwordx4 v[216:219], v39, s[12:15], s63 offen offset:0 sc1
  v_mul_f32 v180, v180, v240
  v_mfma_f32_16x16x32_bf16 v[112:115], a[156:159], a[108:111], v[112:115]
  v_mul_f32 v181, v181, v240
  v_mul_f32 v182, v182, v240
  v_mfma_f32_16x16x32_bf16 v[116:119], a[156:159], a[132:135], v[116:119]
  v_mul_f32 v183, v183, v240
  v_cvt_pk_bf16_f32 v176, v176, v177
  v_mfma_f32_16x16x32_bf16 v[108:111], a[160:163], a[88:91], v[108:111]
  v_cvt_pk_bf16_f32 v177, v178, v179
  v_cvt_pk_bf16_f32 v178, v180, v181
  v_mfma_f32_16x16x32_bf16 v[112:115], a[160:163], a[112:115], v[112:115]
  v_cvt_pk_bf16_f32 v179, v182, v183
  ds_write_b128 v28, v[176:179] offset:9216
  v_mfma_f32_16x16x32_bf16 v[116:119], a[160:163], a[136:139], v[116:119]
  v_cvt_pk_bf16_f32 v54, v96, v97
  v_cvt_pk_bf16_f32 v55, v98, v99
  v_mfma_f32_16x16x32_bf16 v[108:111], a[164:167], a[92:95], v[108:111]
  v_cvt_pk_bf16_f32 v70, v100, v101
  v_cvt_pk_bf16_f32 v71, v102, v103
  v_mfma_f32_16x16x32_bf16 v[112:115], a[164:167], a[116:119], v[112:115]
  buffer_store_dwordx4 v[220:223], v40, s[12:15], s63 offen offset:0 sc1
  v_cvt_pk_bf16_f32 v86, v104, v105
  v_mfma_f32_16x16x32_bf16 v[116:119], a[164:167], a[140:143], v[116:119]
  v_cvt_pk_bf16_f32 v87, v106, v107
  buffer_store_dwordx4 v[224:227], v14, s[12:15], s63 offen offset:0 sc1
  v_cvt_pk_bf16_f32 v56, v108, v109
  v_cvt_pk_bf16_f32 v57, v110, v111
  s_nop 0
  v_cvt_pk_bf16_f32 v72, v112, v113
  v_cvt_pk_bf16_f32 v73, v114, v115
  s_nop 0
  v_cvt_pk_bf16_f32 v88, v116, v117
  v_cvt_pk_bf16_f32 v89, v118, v119
  s_waitcnt lgkmcnt(0)
  s_barrier
  ds_read_b128 v[208:211], v29 offset:8192
  ds_read_b128 v[212:215], v29 offset:9216
  ds_read_b128 v[216:219], v29 offset:10240
  ds_read_b128 v[220:223], v29 offset:11264
  ds_read_b128 v[224:227], v29 offset:12288
  ds_read_b128 v[228:231], v29 offset:13312
  ds_read_b128 v[232:235], v29 offset:14336
  ds_read_b128 v[236:239], v29 offset:15360
  s_waitcnt lgkmcnt(7)
  v_mfma_f32_16x16x32_bf16 v[120:123], v[50:53], v[208:211], 0
  v_mfma_f32_16x16x32_bf16 v[124:127], v[66:69], v[208:211], 0
  v_mfma_f32_16x16x32_bf16 v[128:131], v[82:85], v[208:211], 0
  s_waitcnt lgkmcnt(6)
  v_mfma_f32_16x16x32_bf16 v[120:123], v[54:57], v[212:215], v[120:123]
  v_mfma_f32_16x16x32_bf16 v[124:127], v[70:73], v[212:215], v[124:127]
  v_mfma_f32_16x16x32_bf16 v[128:131], v[86:89], v[212:215], v[128:131]
  s_waitcnt lgkmcnt(5)
  v_mfma_f32_16x16x32_bf16 v[132:135], v[50:53], v[216:219], 0
  v_mfma_f32_16x16x32_bf16 v[136:139], v[66:69], v[216:219], 0
  v_mfma_f32_16x16x32_bf16 v[140:143], v[82:85], v[216:219], 0
  s_waitcnt lgkmcnt(4)
  v_mfma_f32_16x16x32_bf16 v[132:135], v[54:57], v[220:223], v[132:135]
  v_cvt_pk_bf16_f32 v208, v120, v121
  v_cvt_pk_bf16_f32 v209, v122, v123
  v_mfma_f32_16x16x32_bf16 v[136:139], v[70:73], v[220:223], v[136:139]
  v_cvt_pk_bf16_f32 v210, v124, v125
  v_cvt_pk_bf16_f32 v211, v126, v127
  v_mfma_f32_16x16x32_bf16 v[140:143], v[86:89], v[220:223], v[140:143]
  v_cndmask_b32_e64 v214, v46, v41, s[32:33]
  buffer_store_dwordx4 v[208:211], v214, s[12:15], 0 offen offset:0
  s_waitcnt lgkmcnt(3)
  v_mfma_f32_16x16x32_bf16 v[144:147], v[50:53], v[224:227], 0
  v_cvt_pk_bf16_f32 v212, v128, v129
  v_cvt_pk_bf16_f32 v213, v130, v131
  v_mfma_f32_16x16x32_bf16 v[148:151], v[66:69], v[224:227], 0
  v_add_u32 v215, v214, v45
  buffer_store_dwordx2 v[212:213], v215, s[12:15], 0 offen offset:0
  v_mfma_f32_16x16x32_bf16 v[152:155], v[82:85], v[224:227], 0
  s_waitcnt lgkmcnt(2)
  v_mfma_f32_16x16x32_bf16 v[144:147], v[54:57], v[228:231], v[144:147]
  v_cvt_pk_bf16_f32 v216, v132, v133
  v_cvt_pk_bf16_f32 v217, v134, v135
  v_mfma_f32_16x16x32_bf16 v[148:151], v[70:73], v[228:231], v[148:151]
  v_cvt_pk_bf16_f32 v218, v136, v137
  v_cvt_pk_bf16_f32 v219, v138, v139
  v_mfma_f32_16x16x32_bf16 v[152:155], v[86:89], v[228:231], v[152:155]
  buffer_store_dwordx4 v[216:219], v42, s[12:15], 0 offen offset:0
  v_cvt_pk_bf16_f32 v220, v140, v141
  s_waitcnt lgkmcnt(0)
  v_mfma_f32_16x16x32_bf16 v[156:159], v[50:53], v[232:235], 0
  v_cvt_pk_bf16_f32 v221, v142, v143
  v_add_u32 v223, v42, v45
  v_mfma_f32_16x16x32_bf16 v[160:163], v[66:69], v[232:235], 0
  buffer_store_dwordx2 v[220:221], v223, s[12:15], 0 offen offset:0
  v_mfma_f32_16x16x32_bf16 v[164:167], v[82:85], v[232:235], 0
  v_mfma_f32_16x16x32_bf16 v[156:159], v[54:57], v[236:239], v[156:159]
  v_cvt_pk_bf16_f32 v224, v144, v145
  v_cvt_pk_bf16_f32 v225, v146, v147
  v_mfma_f32_16x16x32_bf16 v[160:163], v[70:73], v[236:239], v[160:163]
  v_cvt_pk_bf16_f32 v226, v148, v149
  v_cvt_pk_bf16_f32 v227, v150, v151
  v_mfma_f32_16x16x32_bf16 v[164:167], v[86:89], v[236:239], v[164:167]
  buffer_store_dwordx4 v[224:227], v43, s[12:15], 0 offen offset:0
  v_cvt_pk_bf16_f32 v228, v152, v153
  v_cvt_pk_bf16_f32 v229, v154, v155
  v_add_u32 v231, v43, v45
  buffer_store_dwordx2 v[228:229], v231, s[12:15], 0 offen offset:0
  v_cvt_pk_bf16_f32 v232, v156, v157
  v_cvt_pk_bf16_f32 v233, v158, v159
  v_cvt_pk_bf16_f32 v234, v160, v161
  v_cvt_pk_bf16_f32 v235, v162, v163
  v_cndmask_b32_e64 v238, v44, v46, s[34:35]
  buffer_store_dwordx4 v[232:235], v238, s[12:15], 0 offen offset:0
  v_cvt_pk_bf16_f32 v236, v164, v165
  v_cvt_pk_bf16_f32 v237, v166, v167
  v_add_u32 v239, v238, v45
  buffer_store_dwordx2 v[236:237], v239, s[12:15], 0 offen offset:0
L_end:
  s_endpgm
.section .rodata,"a"
.p2align 6
.amdhsa_kernel standalone__swin_window_attn__vision_kernel
  .amdhsa_next_free_vgpr 512
  .amdhsa_next_free_sgpr 102
  .amdhsa_accum_offset 256
  .amdhsa_group_segment_fixed_size 0
  .amdhsa_kernarg_size 48
  .amdhsa_user_sgpr_count 2
  .amdhsa_user_sgpr_kernarg_segment_ptr 1
  .amdhsa_system_sgpr_workgroup_id_x 1
.end_amdhsa_kernel
```
